```python
import torch

def _softmax(x, axis=-1):
    return torch.softmax(x, dim=axis)
def _gelu(x):
    return torch.nn.functional.gelu(x, approximate="tanh")
def _silu(x):
    return torch.nn.functional.silu(x)
def _sigmoid(x):
    return torch.sigmoid(x)
def _layernorm(x, axis=-1, eps=1e-5):
    m = x.mean(dim=axis, keepdim=True)
    v = x.var(dim=axis, keepdim=True, unbiased=False)
    return (x - m) / torch.sqrt(v + eps)
def _scatter_add(tgt, idx, src, axis=0):
    return tgt.clone().index_add_(axis, idx, src)
def _segment_sum(src, seg, n):
    out = torch.zeros((n,) + src.shape[1:], dtype=src.dtype)
    return out.index_add_(0, seg, src)
def _pad(x, pw):
    flat = tuple(v for pair in reversed(pw) for v in pair)
    return torch.nn.functional.pad(x, flat)

kernel_name = 'standalone__edge_featured_mpnn_egc__graph'

def setup_inputs():

    _w = (lambda a: (lambda t: t.to(torch.bfloat16) if t.is_floating_point() else t)(torch.as_tensor(a)))
    N, deg, D, De = 25000, 32, 64, max(0, 1)
    E = N * deg
    return {
        "x": _w((lambda *s: torch.randn(*s, dtype=torch.bfloat16) * 0.2)(N, D)),
        "e_attr": _w((lambda *s: torch.randn(*s, dtype=torch.bfloat16) * 0.2)(E, De)),
        "src": _w((lambda lo, hi, *s: torch.randint(lo, hi, s))(0, N, E).to(torch.int64)),
        "dst": _w((lambda lo, hi, *s: torch.randint(lo, hi, s))(0, N, E).to(torch.int64)),
        "u_w": _w((lambda *s: torch.randn(*s, dtype=torch.bfloat16) * 0.05)(D, D)),
        "v_w": _w((lambda *s: torch.randn(*s, dtype=torch.bfloat16) * 0.05)(D, D)),
        "g_w": _w((lambda *s: torch.randn(*s, dtype=torch.bfloat16) * 0.2)(2 * D + De, D)),
    }

def reference(x, e_attr, src, dst, u_w, v_w, g_w):
    N, D = x.shape
    g_in = torch.concatenate([x[dst], x[src], e_attr], axis=-1)
    eta = _sigmoid(g_in @ g_w)
    hv = x @ v_w
    msg = eta * hv[src]
    agg = _segment_sum(msg, dst, N)
    return _silu(x @ u_w + agg)
```

```asm
; @launch kernel=k1_kernel grid=(452,1,1) block=(512,1,1) lds=50688
; @launch kernel=k2_kernel grid=(256,1,1) block=(1024,1,1) lds=147456
.amdgcn_target "amdgcn-amd-amdhsa--gfx950"
.text
.globl k1_kernel
.p2align 8
.type k1_kernel,@function
k1_kernel:
  s_cmp_ge_u32 s2, 452
  s_cbranch_scc1 K1_END
  s_load_dwordx2 s[4:5], s[0:1], 72
  s_cmp_lt_u32 s2, 196
  s_cbranch_scc1 K1_TABLE
  s_load_dwordx2 s[6:7], s[0:1], 8
  s_load_dwordx4 s[8:11], s[0:1], 16
  s_sub_u32 s2, s2, 196
  s_mul_i32 s3, s2, 782
  v_add_u32 v1, s3, v0
  v_add_u32 v2, 512, v1
  s_mov_b32 s34, 200000
  v_cmp_gt_u32 s[36:37], s34, v1
  v_cmp_gt_u32 s[38:39], s34, v2
  v_cmp_gt_u32 vcc, 270, v0
  v_lshlrev_b32 v3, 4, v1
  v_lshlrev_b32 v24, 3, v1
  v_lshlrev_b32 v25, 4, v2
  v_lshlrev_b32 v26, 3, v2
  s_and_b64 s[38:39], s[38:39], vcc
  s_waitcnt lgkmcnt(0)
  s_mov_b32 s12, s10
  s_and_b32 s13, s11, 0xffff
  s_mov_b32 s14, 3200000
  s_mov_b32 s15, 0x20000
  s_mov_b32 s16, s8
  s_and_b32 s17, s9, 0xffff
  s_mov_b32 s18, 3200000
  s_mov_b32 s19, 0x20000
  s_mov_b32 s20, s6
  s_and_b32 s21, s7, 0xffff
  s_mov_b32 s22, 1600000
  s_mov_b32 s23, 0x20000
  s_or_b64 exec, s[36:37], 1
  buffer_load_dwordx4 v[4:7], v3, s[12:15], 0 offen
  s_or_b64 exec, s[38:39], 1
  buffer_load_dwordx4 v[14:17], v25, s[12:15], 0 offen
  s_or_b64 exec, s[36:37], 1
  buffer_load_dwordx4 v[8:11], v3, s[16:19], 0 offen
  buffer_load_dwordx2 v[12:13], v24, s[20:23], 0 offen
  s_or_b64 exec, s[38:39], 1
  buffer_load_dwordx4 v[18:21], v25, s[16:19], 0 offen
  buffer_load_dwordx2 v[22:23], v26, s[20:23], 0 offen
  s_mov_b64 exec, -1
  v_cmp_gt_u32 vcc, 130, v0
  v_lshlrev_b32 v1, 2, v0
  v_mov_b32 v2, 0
  s_and_b64 exec, exec, vcc
  ds_write_b32 v1, v2 offset:0
  s_mov_b64 exec, -1
  s_mov_b32 s24, s4
  s_and_b32 s25, s5, 0xffff
  s_mov_b32 s26, 19333120
  s_mov_b32 s27, 0x20000
  s_mov_b32 s42, 5350
  s_movk_i32 s43, -196
  s_mov_b32 s44, 0xffff0000
  s_mov_b32 s62, 0x7fff7fff
  s_mov_b32 s63, 0x41604160
  s_mov_b64 s[64:65], 0
  v_mov_b32 v27, 1
  s_waitcnt lgkmcnt(0)
  s_barrier
  s_waitcnt vmcnt(4)
  s_mov_b64 exec, s[36:37]
  v_mul_u32_u24 v28, s42, v4
  v_mul_u32_u24 v29, s42, v5
  v_mul_u32_u24 v30, s42, v6
  v_mul_u32_u24 v31, s42, v7
  v_lshrrev_b32 v28, 20, v28
  v_lshrrev_b32 v29, 20, v29
  v_lshrrev_b32 v30, 20, v30
  v_lshrrev_b32 v31, 20, v31
  v_mad_i32_i24 v4, v28, s43, v4
  v_mad_i32_i24 v5, v29, s43, v5
  v_mad_i32_i24 v6, v30, s43, v6
  v_mad_i32_i24 v7, v31, s43, v7
  v_lshlrev_b32 v28, 2, v28
  v_lshlrev_b32 v29, 2, v29
  v_lshlrev_b32 v30, 2, v30
  v_lshlrev_b32 v31, 2, v31
  ds_add_rtn_u32 v36, v28, v27 offset:0
  ds_add_rtn_u32 v37, v29, v27 offset:0
  ds_add_rtn_u32 v38, v30, v27 offset:0
  ds_add_rtn_u32 v39, v31, v27 offset:0
  v_lshlrev_b32 v45, 2, v4
  v_lshlrev_b32 v47, 2, v5
  v_lshlrev_b32 v49, 2, v6
  v_lshlrev_b32 v51, 2, v7
  s_mov_b64 exec, s[38:39]
  s_cbranch_execz K1P_A1
  v_mul_u32_u24 v32, s42, v14
  v_mul_u32_u24 v33, s42, v15
  v_mul_u32_u24 v34, s42, v16
  v_mul_u32_u24 v35, s42, v17
  v_lshrrev_b32 v32, 20, v32
  v_lshrrev_b32 v33, 20, v33
  v_lshrrev_b32 v34, 20, v34
  v_lshrrev_b32 v35, 20, v35
  v_mad_i32_i24 v14, v32, s43, v14
  v_mad_i32_i24 v15, v33, s43, v15
  v_mad_i32_i24 v16, v34, s43, v16
  v_mad_i32_i24 v17, v35, s43, v17
  v_lshlrev_b32 v32, 2, v32
  v_lshlrev_b32 v33, 2, v33
  v_lshlrev_b32 v34, 2, v34
  v_lshlrev_b32 v35, 2, v35
  ds_add_rtn_u32 v40, v32, v27 offset:0
  ds_add_rtn_u32 v41, v33, v27 offset:0
  ds_add_rtn_u32 v42, v34, v27 offset:0
  ds_add_rtn_u32 v43, v35, v27 offset:0
  v_lshlrev_b32 v53, 2, v14
  v_lshlrev_b32 v55, 2, v15
  v_lshlrev_b32 v57, 2, v16
  v_lshlrev_b32 v59, 2, v17
K1P_A1:
  s_waitcnt vmcnt(0)
  s_mov_b64 exec, s[36:37]
  v_lshl_or_b32 v44, v12, 16, v8
  v_and_or_b32 v46, v12, s44, v9
  v_lshl_or_b32 v48, v13, 16, v10
  v_and_or_b32 v50, v13, s44, v11
  v_and_b32 v12, s62, v12
  v_and_b32 v13, s62, v13
  v_pk_max_u16 v12, v12, v13
  v_pk_max_u16 v12, v12, s63
  v_cmp_ne_u32 vcc, s63, v12
  s_or_b64 s[64:65], s[64:65], vcc
  s_mov_b64 exec, s[38:39]
  v_lshl_or_b32 v52, v22, 16, v18
  v_and_or_b32 v54, v22, s44, v19
  v_lshl_or_b32 v56, v23, 16, v20
  v_and_or_b32 v58, v23, s44, v21
  v_and_b32 v22, s62, v22
  v_and_b32 v23, s62, v23
  v_pk_max_u16 v22, v22, v23
  v_pk_max_u16 v22, v22, s63
  v_cmp_ne_u32 vcc, s63, v22
  s_or_b64 s[64:65], s[64:65], vcc
  s_mov_b64 exec, -1
  s_waitcnt lgkmcnt(0)
  s_mov_b64 exec, s[36:37]
  v_cmp_gt_u32 s[46:47], 32, v36
  v_cmp_gt_u32 s[48:49], 32, v37
  v_cmp_gt_u32 s[50:51], 32, v38
  v_cmp_gt_u32 s[52:53], 32, v39
  v_mul_u32_u24 v60, 48, v28
  v_mul_u32_u24 v61, 48, v29
  v_mul_u32_u24 v62, 48, v30
  v_mul_u32_u24 v63, 48, v31
  v_lshl_add_u32 v64, v36, 2, v60
  v_lshl_add_u32 v60, v36, 1, v60
  v_lshl_add_u32 v65, v37, 2, v61
  v_lshl_add_u32 v61, v37, 1, v61
  v_lshl_add_u32 v66, v38, 2, v62
  v_lshl_add_u32 v62, v38, 1, v62
  v_lshl_add_u32 v67, v39, 2, v63
  v_lshl_add_u32 v63, v39, 1, v63
  s_mov_b64 exec, s[46:47]
  ds_write_b32 v64, v44 offset:1024
  ds_write_b16 v60, v45 offset:1152
  s_mov_b64 exec, s[48:49]
  ds_write_b32 v65, v46 offset:1024
  ds_write_b16 v61, v47 offset:1152
  s_mov_b64 exec, s[50:51]
  ds_write_b32 v66, v48 offset:1024
  ds_write_b16 v62, v49 offset:1152
  s_mov_b64 exec, s[52:53]
  ds_write_b32 v67, v50 offset:1024
  ds_write_b16 v63, v51 offset:1152
  s_mov_b64 exec, s[38:39]
  v_cmp_gt_u32 s[54:55], 32, v40
  v_cmp_gt_u32 s[56:57], 32, v41
  v_cmp_gt_u32 s[58:59], 32, v42
  v_cmp_gt_u32 s[60:61], 32, v43
  v_mul_u32_u24 v60, 48, v32
  v_mul_u32_u24 v61, 48, v33
  v_mul_u32_u24 v62, 48, v34
  v_mul_u32_u24 v63, 48, v35
  v_lshl_add_u32 v64, v40, 2, v60
  v_lshl_add_u32 v60, v40, 1, v60
  v_lshl_add_u32 v65, v41, 2, v61
  v_lshl_add_u32 v61, v41, 1, v61
  v_lshl_add_u32 v66, v42, 2, v62
  v_lshl_add_u32 v62, v42, 1, v62
  v_lshl_add_u32 v67, v43, 2, v63
  v_lshl_add_u32 v63, v43, 1, v63
  s_mov_b64 exec, s[54:55]
  ds_write_b32 v64, v52 offset:1024
  ds_write_b16 v60, v53 offset:1152
  s_mov_b64 exec, s[56:57]
  ds_write_b32 v65, v54 offset:1024
  ds_write_b16 v61, v55 offset:1152
  s_mov_b64 exec, s[58:59]
  ds_write_b32 v66, v56 offset:1024
  ds_write_b16 v62, v57 offset:1152
  s_mov_b64 exec, s[60:61]
  ds_write_b32 v67, v58 offset:1024
  ds_write_b16 v63, v59 offset:1152
  s_mov_b64 exec, -1
  v_mov_b32 v2, 512
  s_cmp_eq_u64 s[64:65], 0
  s_cbranch_scc1 K1P_EOK
  v_mov_b32 v3, 0x8000
  ds_write_b32 v2, v3 offset:4
K1P_EOK:
  s_andn2_b64 exec, s[36:37], s[46:47]
  s_cbranch_execz K1P_V00
  ds_add_rtn_u32 v3, v2, v27
  v_lshl_or_b32 v45, v28, 14, v45
  s_waitcnt lgkmcnt(0)
  v_lshlrev_b32 v3, 3, v3
  ds_write_b64 v3, v[44:45] offset:25600
K1P_V00:
  s_andn2_b64 exec, s[36:37], s[48:49]
  s_cbranch_execz K1P_V01
  ds_add_rtn_u32 v3, v2, v27
  v_lshl_or_b32 v47, v29, 14, v47
  s_waitcnt lgkmcnt(0)
  v_lshlrev_b32 v3, 3, v3
  ds_write_b64 v3, v[46:47] offset:25600
K1P_V01:
  s_andn2_b64 exec, s[36:37], s[50:51]
  s_cbranch_execz K1P_V02
  ds_add_rtn_u32 v3, v2, v27
  v_lshl_or_b32 v49, v30, 14, v49
  s_waitcnt lgkmcnt(0)
  v_lshlrev_b32 v3, 3, v3
  ds_write_b64 v3, v[48:49] offset:25600
K1P_V02:
  s_andn2_b64 exec, s[36:37], s[52:53]
  s_cbranch_execz K1P_V03
  ds_add_rtn_u32 v3, v2, v27
  v_lshl_or_b32 v51, v31, 14, v51
  s_waitcnt lgkmcnt(0)
  v_lshlrev_b32 v3, 3, v3
  ds_write_b64 v3, v[50:51] offset:25600
K1P_V03:
  s_andn2_b64 exec, s[38:39], s[54:55]
  s_cbranch_execz K1P_V10
  ds_add_rtn_u32 v3, v2, v27
  v_lshl_or_b32 v53, v32, 14, v53
  s_waitcnt lgkmcnt(0)
  v_lshlrev_b32 v3, 3, v3
  ds_write_b64 v3, v[52:53] offset:25600
K1P_V10:
  s_andn2_b64 exec, s[38:39], s[56:57]
  s_cbranch_execz K1P_V11
  ds_add_rtn_u32 v3, v2, v27
  v_lshl_or_b32 v55, v33, 14, v55
  s_waitcnt lgkmcnt(0)
  v_lshlrev_b32 v3, 3, v3
  ds_write_b64 v3, v[54:55] offset:25600
K1P_V11:
  s_andn2_b64 exec, s[38:39], s[58:59]
  s_cbranch_execz K1P_V12
  ds_add_rtn_u32 v3, v2, v27
  v_lshl_or_b32 v57, v34, 14, v57
  s_waitcnt lgkmcnt(0)
  v_lshlrev_b32 v3, 3, v3
  ds_write_b64 v3, v[56:57] offset:25600
K1P_V12:
  s_andn2_b64 exec, s[38:39], s[60:61]
  s_cbranch_execz K1P_V13
  ds_add_rtn_u32 v3, v2, v27
  v_lshl_or_b32 v59, v35, 14, v59
  s_waitcnt lgkmcnt(0)
  v_lshlrev_b32 v3, 3, v3
  ds_write_b64 v3, v[58:59] offset:25600
K1P_V13:
  s_mov_b64 exec, -1
  v_readfirstlane_b32 s3, v0
  v_and_b32 v1, 63, v0
  s_lshr_b32 s3, s3, 6
  v_mul_u32_u24 v3, 43, v1
  v_lshrrev_b32 v3, 9, v3
  v_mul_u32_u24 v4, 12, v3
  v_sub_u32 v4, v1, v4
  s_mul_i32 s40, s3, 3072
  v_lshl_add_u32 v5, v1, 4, s40
  s_mov_b32 s41, 49152
  v_mul_lo_u32 v6, v3, s41
  v_lshl_add_u32 v6, v4, 4, v6
  s_mul_i32 s40, s3, 786432
  v_add_u32 v6, s40, v6
  s_mul_i32 s41, s2, 192
  s_add_u32 s41, s41, 13041664
  s_mov_b32 s44, -1
  s_mov_b32 s45, 0x0fffffff
  s_mov_b32 s66, 0xfff
  s_mov_b32 s67, 0x0
  s_waitcnt lgkmcnt(0)
  s_barrier
  s_mov_b64 exec, s[44:45]
  ds_read_b128 v[8:11], v5 offset:1024
  ds_read_b128 v[12:15], v5 offset:1984
  ds_read_b128 v[16:19], v5 offset:2944
  s_mov_b64 exec, s[66:67]
  ds_read_b128 v[20:23], v5 offset:3904
  s_mov_b64 exec, -1
  v_mov_b32 v30, 0
  ds_read_b64 v[34:35], v30 offset:512
  v_lshlrev_b32 v2, 3, v1
  ds_read_b64 v[28:29], v2 offset:0
  s_mov_b64 exec, s[44:45]
  s_waitcnt lgkmcnt(5)
  buffer_store_dwordx4 v[8:11], v6, s[24:27], s41 offen sc1
  s_add_u32 s41, s41, 245760
  s_waitcnt lgkmcnt(4)
  buffer_store_dwordx4 v[12:15], v6, s[24:27], s41 offen sc1
  s_add_u32 s41, s41, 245760
  s_waitcnt lgkmcnt(3)
  buffer_store_dwordx4 v[16:19], v6, s[24:27], s41 offen sc1
  s_add_u32 s41, s41, 245760
  s_mov_b64 exec, s[66:67]
  s_waitcnt lgkmcnt(2)
  buffer_store_dwordx4 v[20:23], v6, s[24:27], s41 offen sc1
  s_add_u32 s41, s41, 245760
  s_mov_b64 exec, -1
  s_waitcnt lgkmcnt(0)
  v_or_b32 v31, v34, v35
  v_readfirstlane_b32 s42, v34
  s_cmp_lg_u32 s3, 7
  s_cbranch_scc1 K1P_NOOFF
  v_lshl_or_b32 v28, v31, 16, v28
  v_lshl_or_b32 v29, v31, 16, v29
  v_lshlrev_b32 v32, 11, v1
  s_lshl_b32 s40, s2, 2
  s_add_u32 s40, s40, 6422528
  v_add_u32 v32, s40, v32
  buffer_store_dword v28, v32, s[24:27], 0 offen sc1
  buffer_store_dword v29, v32, s[24:27], 0 offen offset:1024 sc1
K1P_NOOFF:
  s_mul_i32 s41, s2, 25024
  v_mov_b32 v7, v0
K1P_OV:
  v_cmp_gt_u32 vcc, s42, v7
  s_and_b64 exec, exec, vcc
  s_cbranch_execz K1P_C0
  v_lshlrev_b32 v24, 3, v7
  ds_read_b64 v[28:29], v24 offset:25600
  v_add_u32 v7, 512, v7
  s_waitcnt lgkmcnt(0)
  buffer_store_dwordx2 v[28:29], v24, s[24:27], s41 offen sc1
  s_branch K1P_OV
K1P_C0:
  s_endpgm
K1_TABLE:
  s_load_dwordx2 s[6:7], s[0:1], 0
  s_load_dwordx4 s[8:11], s[0:1], 40
  v_readfirstlane_b32 s3, v0
  v_and_b32 v3, 63, v0
  v_and_b32 v12, 31, v3
  v_lshrrev_b32 v14, 5, v3
  s_lshr_b32 s36, s3, 6
  s_and_b32 s37, s36, 1
  s_lshr_b32 s36, s36, 1
  s_lshl_b32 s3, s2, 2
  s_add_u32 s3, s3, s36
  s_lshl_b32 s38, s3, 5
  v_lshlrev_b32 v1, 4, v0
  v_add_u32 v2, 8192, v1
  s_lshl_b32 s39, s2, 14
  v_add_u32 v13, s39, v1
  s_waitcnt lgkmcnt(0)
  global_load_dwordx4 v[4:7], v2, s[10:11]
  global_load_dwordx4 v[8:11], v1, s[8:9]
  s_mov_b32 s12, s6
  s_and_b32 s13, s7, 0xffff
  s_mov_b32 s14, 3200000
  s_mov_b32 s15, 0x20000
  s_mov_b32 s39, 8192
  buffer_load_dwordx4 v[16:19], v13, s[12:15], 0 offen
  v_add_u32 v13, s39, v13
  buffer_load_dwordx4 v[20:23], v13, s[12:15], 0 offen
  s_movk_i32 s39, 144
  v_lshrrev_b32 v24, 3, v0
  v_and_b32 v25, 7, v0
  v_lshlrev_b32 v25, 4, v25
  v_mad_u32_u24 v24, v24, s39, v25
  s_lshl_b32 s3, s36, 5
  v_add_u32 v97, s3, v12
  v_lshlrev_b32 v26, 4, v14
  v_mad_u32_u24 v97, v97, s39, v26
  v_mov_b32 v2, 0
  v_mov_b32 v15, 16384
  ds_write_b32 v15, v2
  v_lshlrev_b32 v15, 3, v14
  v_bfe_u32 v2, v3, 2, 2
  v_add_u32 v15, v15, v2
  v_lshlrev_b32 v15, 7, v15
  v_bfe_u32 v2, v3, 4, 1
  v_lshl_add_u32 v15, v2, 5, v15
  v_and_b32 v2, 3, v3
  v_lshl_add_u32 v15, v2, 3, v15
  s_lshl_b32 s3, s37, 6
  v_add_u32 v15, s3, v15
  s_mov_b32 s24, s4
  s_and_b32 s25, s5, 0xffff
  s_mov_b32 s26, 19333120
  s_mov_b32 s27, 0x20000
  s_mul_i32 s3, s37, 3211264
  s_lshl_b32 s39, s38, 7
  s_add_u32 s3, s3, s39
  s_add_u32 s3, s3, 6553600
  v_lshlrev_b32 v33, 9, v14
  v_lshl_add_u32 v33, v12, 2, v33
  v_add_u32 v96, s3, v33
  s_mov_b32 s40, 0xbfb8aa3b
  s_mov_b32 s42, 0xffff0000
  s_waitcnt vmcnt(2)
  ds_write_b128 v1, v[4:7] offset:0
  ds_write_b128 v1, v[8:11] offset:8192
  s_waitcnt vmcnt(0)
  ds_write_b128 v24, v[16:19] offset:16448
  ds_write_b128 v24, v[20:23] offset:25664
  s_waitcnt lgkmcnt(0)
  s_barrier
  ds_read_b128 v[16:19], v97 offset:16448
  ds_read_b128 v[20:23], v97 offset:16480
  ds_read_b128 v[24:27], v97 offset:16512
  ds_read_b128 v[28:31], v97 offset:16544
  ds_read_b64_tr_b16 v[32:33], v15 offset:0
  ds_read_b64_tr_b16 v[34:35], v15 offset:512
  ds_read_b64_tr_b16 v[36:37], v15 offset:2048
  ds_read_b64_tr_b16 v[38:39], v15 offset:2560
  ds_read_b64_tr_b16 v[40:41], v15 offset:4096
  ds_read_b64_tr_b16 v[42:43], v15 offset:4608
  ds_read_b64_tr_b16 v[44:45], v15 offset:6144
  ds_read_b64_tr_b16 v[46:47], v15 offset:6656
  ds_read_b64_tr_b16 v[48:49], v15 offset:8192
  ds_read_b64_tr_b16 v[50:51], v15 offset:8704
  ds_read_b64_tr_b16 v[52:53], v15 offset:10240
  ds_read_b64_tr_b16 v[54:55], v15 offset:10752
  ds_read_b64_tr_b16 v[56:57], v15 offset:12288
  ds_read_b64_tr_b16 v[58:59], v15 offset:12800
  ds_read_b64_tr_b16 v[60:61], v15 offset:14336
  ds_read_b64_tr_b16 v[62:63], v15 offset:14848
  s_waitcnt lgkmcnt(8)
  v_mfma_f32_32x32x16_bf16 v[64:79], v[16:19], v[32:35], 0
  v_mfma_f32_32x32x16_bf16 v[64:79], v[20:23], v[36:39], v[64:79]
  v_mfma_f32_32x32x16_bf16 v[64:79], v[24:27], v[40:43], v[64:79]
  v_mfma_f32_32x32x16_bf16 v[64:79], v[28:31], v[44:47], v[64:79]
  s_waitcnt lgkmcnt(0)
  v_mfma_f32_32x32x16_bf16 v[80:95], v[16:19], v[48:51], 0
  v_mfma_f32_32x32x16_bf16 v[80:95], v[20:23], v[52:55], v[80:95]
  v_mfma_f32_32x32x16_bf16 v[80:95], v[24:27], v[56:59], v[80:95]
  v_mfma_f32_32x32x16_bf16 v[80:95], v[28:31], v[60:63], v[80:95]
  s_nop 7
  v_mov_b32 v5, 0
  v_pk_mul_f32 v[64:65], v[64:65], s[40:41] op_sel_hi:[1,0]
  v_pk_mul_f32 v[66:67], v[66:67], s[40:41] op_sel_hi:[1,0]
  v_pk_mul_f32 v[68:69], v[68:69], s[40:41] op_sel_hi:[1,0]
  v_pk_mul_f32 v[70:71], v[70:71], s[40:41] op_sel_hi:[1,0]
  v_pk_mul_f32 v[72:73], v[72:73], s[40:41] op_sel_hi:[1,0]
  v_pk_mul_f32 v[74:75], v[74:75], s[40:41] op_sel_hi:[1,0]
  v_pk_mul_f32 v[76:77], v[76:77], s[40:41] op_sel_hi:[1,0]
  v_pk_mul_f32 v[78:79], v[78:79], s[40:41] op_sel_hi:[1,0]
  v_max3_f32 v5, |v64|, |v65|, v5
  v_max3_f32 v5, |v66|, |v67|, v5
  v_max3_f32 v5, |v68|, |v69|, v5
  v_max3_f32 v5, |v70|, |v71|, v5
  v_max3_f32 v5, |v72|, |v73|, v5
  v_max3_f32 v5, |v74|, |v75|, v5
  v_max3_f32 v5, |v76|, |v77|, v5
  v_max3_f32 v5, |v78|, |v79|, v5
  v_mov_b32 v6, 0
  v_max3_f32 v6, |v80|, |v81|, v6
  v_max3_f32 v6, |v82|, |v83|, v6
  v_max3_f32 v6, |v84|, |v85|, v6
  v_max3_f32 v6, |v86|, |v87|, v6
  v_max3_f32 v6, |v88|, |v89|, v6
  v_max3_f32 v6, |v90|, |v91|, v6
  v_max3_f32 v6, |v92|, |v93|, v6
  v_max3_f32 v6, |v94|, |v95|, v6
  v_exp_f32 v64, v64
  v_exp_f32 v65, v65
  v_exp_f32 v66, v66
  v_exp_f32 v67, v67
  v_exp_f32 v68, v68
  v_exp_f32 v69, v69
  v_exp_f32 v70, v70
  v_exp_f32 v71, v71
  v_exp_f32 v72, v72
  v_exp_f32 v73, v73
  v_exp_f32 v74, v74
  v_exp_f32 v75, v75
  v_exp_f32 v76, v76
  v_exp_f32 v77, v77
  v_exp_f32 v78, v78
  v_exp_f32 v79, v79
  v_cvt_f16_f32 v64, v64
  v_cvt_f16_f32 v65, v65
  v_cvt_f16_f32 v66, v66
  v_cvt_f16_f32 v67, v67
  v_cvt_f16_f32 v68, v68
  v_cvt_f16_f32 v69, v69
  v_cvt_f16_f32 v70, v70
  v_cvt_f16_f32 v71, v71
  v_cvt_f16_f32 v72, v72
  v_cvt_f16_f32 v73, v73
  v_cvt_f16_f32 v74, v74
  v_cvt_f16_f32 v75, v75
  v_cvt_f16_f32 v76, v76
  v_cvt_f16_f32 v77, v77
  v_cvt_f16_f32 v78, v78
  v_cvt_f16_f32 v79, v79
  v_sub_u32 v80, v80, v64
  v_sub_u32 v81, v81, v65
  v_sub_u32 v82, v82, v66
  v_sub_u32 v83, v83, v67
  v_sub_u32 v84, v84, v68
  v_sub_u32 v85, v85, v69
  v_sub_u32 v86, v86, v70
  v_sub_u32 v87, v87, v71
  v_sub_u32 v88, v88, v72
  v_sub_u32 v89, v89, v73
  v_sub_u32 v90, v90, v74
  v_sub_u32 v91, v91, v75
  v_sub_u32 v92, v92, v76
  v_sub_u32 v93, v93, v77
  v_sub_u32 v94, v94, v78
  v_sub_u32 v95, v95, v79
  v_add_u32 v80, 0x8000, v80
  v_add_u32 v81, 0x8000, v81
  v_add_u32 v82, 0x8000, v82
  v_add_u32 v83, 0x8000, v83
  v_add_u32 v84, 0x8000, v84
  v_add_u32 v85, 0x8000, v85
  v_add_u32 v86, 0x8000, v86
  v_add_u32 v87, 0x8000, v87
  v_add_u32 v88, 0x8000, v88
  v_add_u32 v89, 0x8000, v89
  v_add_u32 v90, 0x8000, v90
  v_add_u32 v91, 0x8000, v91
  v_add_u32 v92, 0x8000, v92
  v_add_u32 v93, 0x8000, v93
  v_add_u32 v94, 0x8000, v94
  v_add_u32 v95, 0x8000, v95
  v_and_or_b32 v80, v80, s42, v64
  buffer_store_dword v80, v96, s[24:27], 0 offen offset:0 sc1
  v_and_or_b32 v81, v81, s42, v65
  buffer_store_dword v81, v96, s[24:27], 0 offen offset:128 sc1
  v_and_or_b32 v82, v82, s42, v66
  buffer_store_dword v82, v96, s[24:27], 0 offen offset:256 sc1
  v_and_or_b32 v83, v83, s42, v67
  buffer_store_dword v83, v96, s[24:27], 0 offen offset:384 sc1
  v_and_or_b32 v84, v84, s42, v68
  buffer_store_dword v84, v96, s[24:27], 0 offen offset:1024 sc1
  v_and_or_b32 v85, v85, s42, v69
  buffer_store_dword v85, v96, s[24:27], 0 offen offset:1152 sc1
  v_and_or_b32 v86, v86, s42, v70
  buffer_store_dword v86, v96, s[24:27], 0 offen offset:1280 sc1
  v_and_or_b32 v87, v87, s42, v71
  buffer_store_dword v87, v96, s[24:27], 0 offen offset:1408 sc1
  v_and_or_b32 v88, v88, s42, v72
  buffer_store_dword v88, v96, s[24:27], 0 offen offset:2048 sc1
  v_and_or_b32 v89, v89, s42, v73
  buffer_store_dword v89, v96, s[24:27], 0 offen offset:2176 sc1
  v_and_or_b32 v90, v90, s42, v74
  buffer_store_dword v90, v96, s[24:27], 0 offen offset:2304 sc1
  v_and_or_b32 v91, v91, s42, v75
  buffer_store_dword v91, v96, s[24:27], 0 offen offset:2432 sc1
  v_and_or_b32 v92, v92, s42, v76
  buffer_store_dword v92, v96, s[24:27], 0 offen offset:3072 sc1
  v_and_or_b32 v93, v93, s42, v77
  buffer_store_dword v93, v96, s[24:27], 0 offen offset:3200 sc1
  v_and_or_b32 v94, v94, s42, v78
  buffer_store_dword v94, v96, s[24:27], 0 offen offset:3328 sc1
  v_and_or_b32 v95, v95, s42, v79
  buffer_store_dword v95, v96, s[24:27], 0 offen offset:3456 sc1
  v_mov_b32 v7, 0x41600000
  v_cmp_nle_f32 vcc, v5, v7
  v_mov_b32 v7, 0x5d800000
  v_cmp_nle_f32 s[32:33], v6, v7
  s_or_b64 vcc, vcc, s[32:33]
  s_cbranch_vccz K1T_OK
  v_mov_b32 v2, 1
  v_mov_b32 v1, 16384
  ds_write_b32 v1, v2
K1T_OK:
  s_waitcnt lgkmcnt(0)
  s_barrier
  v_cmp_eq_u32 vcc, 0, v0
  s_and_saveexec_b64 s[32:33], vcc
  s_cbranch_execz K1_END
  v_mov_b32 v1, 16384
  ds_read_b32 v2, v1
  s_lshl_b32 s3, s2, 2
  s_add_u32 s3, s3, 12976128
  v_mov_b32 v3, s3
  s_waitcnt lgkmcnt(0)
  buffer_store_dword v2, v3, s[24:27], 0 offen sc1
K1_END:
  s_endpgm
.text
.globl k2_kernel
.p2align 8
.type k2_kernel,@function
k2_kernel:
  s_cmp_ge_u32 s2, 256
  s_cbranch_scc1 K2_END
  s_setprio 3
  s_load_dwordx2 s[4:5], s[0:1], 72
  s_load_dwordx2 s[6:7], s[0:1], 0
  s_load_dwordx2 s[8:9], s[0:1], 32
  s_load_dwordx4 s[44:47], s[0:1], 48
  v_readfirstlane_b32 s35, v0
  v_and_b32 v1, 63, v0
  s_lshr_b32 s33, s2, 1
  s_and_b32 s34, s2, 1
  v_and_b32 v2, 3, v1
  v_lshrrev_b32 v3, 4, v1
  s_lshr_b32 s35, s35, 6
  v_lshl_add_u32 v2, v2, 2, v3
  s_lshl_b32 s92, s33, 10
  s_lshl_b32 s3, s35, 6
  s_add_u32 s92, s92, s3
  s_add_u32 s92, s92, 6422528
  v_lshlrev_b32 v4, 2, v2
  s_mul_i32 s93, s33, 49152
  s_mul_i32 s3, s35, 3072
  s_add_u32 s93, s93, s3
  s_add_u32 s93, s93, 13041664
  s_movk_i32 s3, 192
  v_and_b32 v7, 15, v1
  v_lshlrev_b32 v12, 2, v7
  v_lshlrev_b32 v7, 3, v7
  v_mad_u32_u24 v7, v3, s3, v7
  v_mad_u32_u24 v12, v3, s3, v12
  s_lshl_b32 s38, s34, 6
  s_waitcnt lgkmcnt(0)
  s_mov_b32 s16, s4
  s_and_b32 s17, s5, 0xffff
  s_mov_b32 s18, 19333120
  s_mov_b32 s19, 0x20000
  buffer_load_dword v4, v4, s[16:19], s92 offen
  buffer_load_dwordx2 v[28:29], v7, s[16:19], s93 offen offset:0
  buffer_load_dword v30, v12, s[16:19], s93 offen offset:128
  buffer_load_dwordx2 v[32:33], v7, s[16:19], s93 offen offset:768
  buffer_load_dword v34, v12, s[16:19], s93 offen offset:896
  buffer_load_dwordx2 v[36:37], v7, s[16:19], s93 offen offset:1536
  buffer_load_dword v38, v12, s[16:19], s93 offen offset:1664
  buffer_load_dwordx2 v[40:41], v7, s[16:19], s93 offen offset:2304
  buffer_load_dword v42, v12, s[16:19], s93 offen offset:2432
  s_cmp_lt_u32 s35, 8
  s_cbranch_scc1 K2_NOW
  s_cmp_lt_u32 s35, 12
  s_cselect_b32 s40, s44, s8
  s_cselect_b32 s41, s45, s9
  v_and_b32 v5, 255, v0
  v_lshrrev_b32 v6, 2, v5
  v_and_b32 v12, 3, v0
  v_lshlrev_b32 v6, 7, v6
  v_lshl_add_u32 v6, v12, 4, v6
  v_add_u32 v6, s38, v6
  global_load_dwordx4 v[8:11], v6, s[40:41]
  s_cmp_lg_u32 s35, 15
  s_cbranch_scc1 K2_NOW
  v_and_b32 v13, 31, v1
  v_lshlrev_b32 v13, 1, v13
  s_add_u32 s3, s38, 16384
  v_add_u32 v13, s3, v13
  global_load_ushort v14, v13, s[44:45]
  v_min_u32 v13, 48, v1
  v_lshlrev_b32 v13, 4, v13
  s_mov_b32 s3, 12976128
  buffer_load_dwordx4 v[16:19], v13, s[16:19], s3 offen
K2_NOW:
  s_setprio 0
  v_mov_b32 v24, 25000
  v_mov_b32 v25, 25000
  v_mov_b32 v26, 25000
  v_mov_b32 v27, 25000
  v_lshlrev_b32 v21, 4, v0
  v_add_u32 v21, 65536, v21
  ds_write_b128 v21, v[24:27] offset:0
  ds_write_b128 v21, v[24:27] offset:16384
  ds_write_b128 v21, v[24:27] offset:32768
  ds_write_b128 v21, v[24:27] offset:49152
  s_cmp_ge_u32 s35, 6
  s_cbranch_scc1 K2_Z
  s_movk_i32 s3, 324
  v_cmp_gt_u32 vcc, 256, v0
  v_mov_b32 v22, 65536
  v_mad_u32_u24 v22, v0, s3, v22
  v_lshlrev_b32 v23, 2, v0
  v_cndmask_b32 v22, 0, v22, vcc
  ds_write_b32 v23, v22 offset:57600
K2_Z:
  s_movk_i32 s3, 25024
  v_mul_u32_u24 v5, s3, v2
  v_and_b32 v22, 15, v1
  v_lshlrev_b32 v22, 1, v22
  v_or_b32 v23, 1, v22
  s_mul_i32 s37, s35, 400384
  s_cmp_lt_u32 s35, 8
  s_cbranch_scc1 K2_W0
  s_cmp_eq_u32 s35, 15
  s_cbranch_scc1 K2_W2
  s_waitcnt vmcnt(9)
  s_branch K2_W1
K2_W2:
  s_waitcnt vmcnt(11)
  s_branch K2_W1
K2_W0:
  s_waitcnt vmcnt(8)
K2_W1:
  s_setprio 2
  v_and_b32 v6, 0xffff, v4
  v_bfe_u32 v20, v4, 16, 15
  v_cmp_gt_i32 vcc, 0, v4
  s_cmp_lg_u64 vcc, 0
  s_cselect_b32 s39, 1, 0
  v_cmp_lt_u32 vcc, 32, v6
  s_mov_b32 s43, 0
  v_mov_b32_dpp v92, v6 row_newbcast:0 row_mask:0xf bank_mask:0xf
  v_mov_b32_dpp v93, v6 row_newbcast:1 row_mask:0xf bank_mask:0xf
  v_mov_b32_dpp v94, v6 row_newbcast:2 row_mask:0xf bank_mask:0xf
  v_mov_b32_dpp v95, v6 row_newbcast:3 row_mask:0xf bank_mask:0xf
  s_and_b32 s40, vcc_lo, 0x000f000f
  s_and_b32 s41, vcc_hi, 0x000f000f
  v_cmp_gt_u32 s[58:59], v92, v22
  v_cmp_gt_u32 s[60:61], v92, v23
  v_cmp_gt_u32 s[62:63], v93, v22
  v_cmp_gt_u32 s[64:65], v93, v23
  v_cmp_gt_u32 s[66:67], v94, v22
  v_cmp_gt_u32 s[68:69], v94, v23
  v_cmp_gt_u32 s[70:71], v95, v22
  v_cmp_gt_u32 s[72:73], v95, v23
  s_cmp_eq_u64 s[40:41], 0
  s_cbranch_scc1 K2_XDONE
  v_lshlrev_b32 v21, 3, v1
  s_mov_b32 s95, 0
  s_ff1_i32_b64 s42, s[40:41]
  s_mov_b64 s[56:57], s[40:41]
  v_readlane_b32 s90, v5, s42
  v_readlane_b32 s91, v20, s42
  s_bitset0_b64 s[56:57], s42
  s_add_u32 s43, s43, 1
  s_lshl_b32 s3, s95, 3
  s_add_u32 s90, s90, s37
  s_add_u32 s90, s90, s3
  s_sub_u32 s91, s91, s95
  s_cmp_gt_u32 s91, 64
  s_cselect_b32 s94, 64, 0
  s_cmp_lg_u32 s95, 0
  s_cselect_b32 s3, s94, 0
  s_cselect_b32 s95, 0, s94
  s_or_b32 s39, s39, s3
  s_cmp_eq_u32 s95, 0
  s_cselect_b64 s[40:41], s[56:57], s[40:41]
  v_cmp_gt_u32 s[74:75], s91, v1
  s_nop 0
  s_mov_b64 exec, s[74:75]
  buffer_load_dwordx2 v[44:45], v21, s[16:19], s90 offen
  s_mov_b64 exec, -1
  s_cmp_eq_u64 s[40:41], 0
  s_cbranch_scc1 K2_XDONE
  s_ff1_i32_b64 s42, s[40:41]
  s_mov_b64 s[56:57], s[40:41]
  v_readlane_b32 s90, v5, s42
  v_readlane_b32 s91, v20, s42
  s_bitset0_b64 s[56:57], s42
  s_add_u32 s43, s43, 1
  s_lshl_b32 s3, s95, 3
  s_add_u32 s90, s90, s37
  s_add_u32 s90, s90, s3
  s_sub_u32 s91, s91, s95
  s_cmp_gt_u32 s91, 64
  s_cselect_b32 s94, 64, 0
  s_cmp_lg_u32 s95, 0
  s_cselect_b32 s3, s94, 0
  s_cselect_b32 s95, 0, s94
  s_or_b32 s39, s39, s3
  s_cmp_eq_u32 s95, 0
  s_cselect_b64 s[40:41], s[56:57], s[40:41]
  v_cmp_gt_u32 s[76:77], s91, v1
  s_nop 0
  s_mov_b64 exec, s[76:77]
  buffer_load_dwordx2 v[46:47], v21, s[16:19], s90 offen
  s_mov_b64 exec, -1
  s_cmp_eq_u64 s[40:41], 0
  s_cbranch_scc1 K2_XDONE
  s_ff1_i32_b64 s42, s[40:41]
  s_mov_b64 s[56:57], s[40:41]
  v_readlane_b32 s90, v5, s42
  v_readlane_b32 s91, v20, s42
  s_bitset0_b64 s[56:57], s42
  s_add_u32 s43, s43, 1
  s_lshl_b32 s3, s95, 3
  s_add_u32 s90, s90, s37
  s_add_u32 s90, s90, s3
  s_sub_u32 s91, s91, s95
  s_cmp_gt_u32 s91, 64
  s_cselect_b32 s94, 64, 0
  s_cmp_lg_u32 s95, 0
  s_cselect_b32 s3, s94, 0
  s_cselect_b32 s95, 0, s94
  s_or_b32 s39, s39, s3
  s_cmp_eq_u32 s95, 0
  s_cselect_b64 s[40:41], s[56:57], s[40:41]
  v_cmp_gt_u32 s[78:79], s91, v1
  s_nop 0
  s_mov_b64 exec, s[78:79]
  buffer_load_dwordx2 v[48:49], v21, s[16:19], s90 offen
  s_mov_b64 exec, -1
  s_cmp_eq_u64 s[40:41], 0
  s_cbranch_scc1 K2_XDONE
  s_ff1_i32_b64 s42, s[40:41]
  s_mov_b64 s[56:57], s[40:41]
  v_readlane_b32 s90, v5, s42
  v_readlane_b32 s91, v20, s42
  s_bitset0_b64 s[56:57], s42
  s_add_u32 s43, s43, 1
  s_lshl_b32 s3, s95, 3
  s_add_u32 s90, s90, s37
  s_add_u32 s90, s90, s3
  s_sub_u32 s91, s91, s95
  s_cmp_gt_u32 s91, 64
  s_cselect_b32 s94, 64, 0
  s_cmp_lg_u32 s95, 0
  s_cselect_b32 s3, s94, 0
  s_cselect_b32 s95, 0, s94
  s_or_b32 s39, s39, s3
  s_cmp_eq_u32 s95, 0
  s_cselect_b64 s[40:41], s[56:57], s[40:41]
  v_cmp_gt_u32 s[80:81], s91, v1
  s_nop 0
  s_mov_b64 exec, s[80:81]
  buffer_load_dwordx2 v[50:51], v21, s[16:19], s90 offen
  s_mov_b64 exec, -1
  s_cmp_eq_u64 s[40:41], 0
  s_cbranch_scc1 K2_XDONE
  s_ff1_i32_b64 s42, s[40:41]
  s_mov_b64 s[56:57], s[40:41]
  v_readlane_b32 s90, v5, s42
  v_readlane_b32 s91, v20, s42
  s_bitset0_b64 s[56:57], s42
  s_add_u32 s43, s43, 1
  s_lshl_b32 s3, s95, 3
  s_add_u32 s90, s90, s37
  s_add_u32 s90, s90, s3
  s_sub_u32 s91, s91, s95
  s_cmp_gt_u32 s91, 64
  s_cselect_b32 s94, 64, 0
  s_cmp_lg_u32 s95, 0
  s_cselect_b32 s3, s94, 0
  s_cselect_b32 s95, 0, s94
  s_or_b32 s39, s39, s3
  s_cmp_eq_u32 s95, 0
  s_cselect_b64 s[40:41], s[56:57], s[40:41]
  v_cmp_gt_u32 s[82:83], s91, v1
  s_nop 0
  s_mov_b64 exec, s[82:83]
  buffer_load_dwordx2 v[52:53], v21, s[16:19], s90 offen
  s_mov_b64 exec, -1
  s_cmp_eq_u64 s[40:41], 0
  s_cbranch_scc1 K2_XDONE
  s_ff1_i32_b64 s42, s[40:41]
  s_mov_b64 s[56:57], s[40:41]
  v_readlane_b32 s90, v5, s42
  v_readlane_b32 s91, v20, s42
  s_bitset0_b64 s[56:57], s42
  s_add_u32 s43, s43, 1
  s_lshl_b32 s3, s95, 3
  s_add_u32 s90, s90, s37
  s_add_u32 s90, s90, s3
  s_sub_u32 s91, s91, s95
  s_cmp_gt_u32 s91, 64
  s_cselect_b32 s94, 64, 0
  s_cmp_lg_u32 s95, 0
  s_cselect_b32 s3, s94, 0
  s_cselect_b32 s95, 0, s94
  s_or_b32 s39, s39, s3
  s_cmp_eq_u32 s95, 0
  s_cselect_b64 s[40:41], s[56:57], s[40:41]
  v_cmp_gt_u32 s[84:85], s91, v1
  s_nop 0
  s_mov_b64 exec, s[84:85]
  buffer_load_dwordx2 v[54:55], v21, s[16:19], s90 offen
  s_mov_b64 exec, -1
  s_cmp_eq_u64 s[40:41], 0
  s_cbranch_scc1 K2_XDONE
  s_ff1_i32_b64 s42, s[40:41]
  s_mov_b64 s[56:57], s[40:41]
  v_readlane_b32 s90, v5, s42
  v_readlane_b32 s91, v20, s42
  s_bitset0_b64 s[56:57], s42
  s_add_u32 s43, s43, 1
  s_lshl_b32 s3, s95, 3
  s_add_u32 s90, s90, s37
  s_add_u32 s90, s90, s3
  s_sub_u32 s91, s91, s95
  s_cmp_gt_u32 s91, 64
  s_cselect_b32 s94, 64, 0
  s_cmp_lg_u32 s95, 0
  s_cselect_b32 s3, s94, 0
  s_cselect_b32 s95, 0, s94
  s_or_b32 s39, s39, s3
  s_cmp_eq_u32 s95, 0
  s_cselect_b64 s[40:41], s[56:57], s[40:41]
  v_cmp_gt_u32 s[86:87], s91, v1
  s_nop 0
  s_mov_b64 exec, s[86:87]
  buffer_load_dwordx2 v[56:57], v21, s[16:19], s90 offen
  s_mov_b64 exec, -1
  s_cmp_eq_u64 s[40:41], 0
  s_cbranch_scc1 K2_XDONE
  s_ff1_i32_b64 s42, s[40:41]
  s_mov_b64 s[56:57], s[40:41]
  v_readlane_b32 s90, v5, s42
  v_readlane_b32 s91, v20, s42
  s_bitset0_b64 s[56:57], s42
  s_add_u32 s43, s43, 1
  s_lshl_b32 s3, s95, 3
  s_add_u32 s90, s90, s37
  s_add_u32 s90, s90, s3
  s_sub_u32 s91, s91, s95
  s_cmp_gt_u32 s91, 64
  s_cselect_b32 s94, 64, 0
  s_cmp_lg_u32 s95, 0
  s_cselect_b32 s3, s94, 0
  s_cselect_b32 s95, 0, s94
  s_or_b32 s39, s39, s3
  s_cmp_eq_u32 s95, 0
  s_cselect_b64 s[40:41], s[56:57], s[40:41]
  v_cmp_gt_u32 s[88:89], s91, v1
  s_nop 0
  s_mov_b64 exec, s[88:89]
  buffer_load_dwordx2 v[58:59], v21, s[16:19], s90 offen
  s_mov_b64 exec, -1
  s_cmp_eq_u64 s[40:41], 0
  s_cbranch_scc1 K2_XDONE
  s_mov_b32 s39, 1
K2_XDONE:
  s_setprio 0
  s_sub_u32 s36, s35, 4
  s_cmp_lt_u32 s36, 7
  s_cbranch_scc0 K2_NOX
  s_mov_b32 s12, s6
  s_and_b32 s13, s7, 0xffff
  s_mov_b32 s14, 3200000
  s_mov_b32 s15, 0x20000
  s_mul_i32 s3, s33, 196
  s_lshl_b32 s37, s36, 5
  s_add_u32 s3, s3, s37
  v_lshrrev_b32 v3, 5, v1
  v_and_b32 v12, 31, v1
  v_add_u32 v13, s3, v12
  v_lshlrev_b32 v13, 7, v13
  v_lshl_add_u32 v13, v3, 4, v13
K2_NOX:
  s_cmp_lg_u32 s35, 15
  s_cbranch_scc1 K2_NOF
  s_waitcnt vmcnt(0)
  v_or3_b32 v16, v16, v17, v18
  v_or_b32 v16, v16, v19
  v_cmp_ne_u32 vcc, 0, v16
  s_mov_b32 s3, 0xbfb8aa3b
  v_lshlrev_b32 v14, 16, v14
  v_mul_f32 v14, s3, v14
  s_mov_b64 s[40:41], vcc
  v_cmp_nle_f32 vcc, |v14|, 2.0
  s_or_b64 vcc, vcc, s[40:41]
  s_cmp_lg_u64 vcc, 0
  s_cselect_b32 s3, 1, 0
  v_mov_b32 v16, s3
  v_mov_b32 v17, 0
  v_mov_b32 v18, 61376
  ds_write_b64 v18, v[16:17]
  ds_write_b32 v18, v17 offset:8
  ds_write_b32 v18, v17 offset:12
  ds_write_b32 v18, v17 offset:16
  v_lshlrev_b32 v12, 2, v1
  v_cmp_gt_u32 vcc, 32, v1
  s_and_saveexec_b64 s[56:57], vcc
  ds_write_b32 v12, v14 offset:61248
  ds_write_b32 v12, v17 offset:61440
  s_mov_b64 exec, s[56:57]
K2_NOF:
  s_mul_i32 s3, s34, 3211264
  s_add_u32 s3, s3, 6553600
  s_add_u32 s40, s4, s3
  s_addc_u32 s41, s5, 0
  s_mov_b32 s24, s40
  s_and_b32 s25, s41, 0xffff
  s_or_b32 s25, s25, 0x800000
  s_mov_b32 s26, 25088
  s_mov_b32 s27, 0x20000
  v_mov_b32 v24, 4
  v_mov_b32 v25, s33
  v_lshlrev_b32 v20, 4, v0
  v_add_u32 v20, 122880, v20
  s_waitcnt vmcnt(0)
  v_lshrrev_b32 v31, 16, v30
  v_and_b32 v30, 0xffff, v30
  v_lshrrev_b32 v35, 16, v34
  v_and_b32 v34, 0xffff, v34
  v_lshrrev_b32 v39, 16, v38
  v_and_b32 v38, 0xffff, v38
  v_lshrrev_b32 v43, 16, v42
  v_and_b32 v42, 0xffff, v42
  s_cmp_lt_u32 s35, 8
  s_cbranch_scc1 K2_NOW2
  ds_write_b128 v20, v[8:11]
K2_NOW2:
  s_cmp_lt_u32 s36, 7
  s_cbranch_scc0 K2_NOX2
  buffer_load_dwordx4 v[64:67], v13, s[12:15], 0 offen offset:0
  buffer_load_dwordx4 v[68:71], v13, s[12:15], 0 offen offset:32
  buffer_load_dwordx4 v[72:75], v13, s[12:15], 0 offen offset:64
  buffer_load_dwordx4 v[76:79], v13, s[12:15], 0 offen offset:96
K2_NOX2:
  s_waitcnt lgkmcnt(0)
  s_barrier
  s_cmp_eq_u32 s39, 0
  s_cbranch_scc1 K2_NOGEN
  v_mov_b32 v16, 1
  v_mov_b32 v18, 61376
  ds_write_b32 v18, v16
K2_NOGEN:
  s_mov_b64 exec, s[58:59]
  ds_add_rtn_u32 v100, v30, v24 offset:57600
  s_mov_b64 exec, s[60:61]
  ds_add_rtn_u32 v101, v31, v24 offset:57600
  s_mov_b64 exec, s[62:63]
  ds_add_rtn_u32 v102, v34, v24 offset:57600
  s_mov_b64 exec, s[64:65]
  ds_add_rtn_u32 v103, v35, v24 offset:57600
  s_mov_b64 exec, s[66:67]
  ds_add_rtn_u32 v104, v38, v24 offset:57600
  s_mov_b64 exec, s[68:69]
  ds_add_rtn_u32 v105, v39, v24 offset:57600
  s_mov_b64 exec, s[70:71]
  ds_add_rtn_u32 v106, v42, v24 offset:57600
  s_mov_b64 exec, s[72:73]
  ds_add_rtn_u32 v107, v43, v24 offset:57600
  s_cmp_le_u32 s43, 0
  s_cbranch_scc1 K2_AX
  s_mov_b64 exec, s[74:75]
  v_cmp_eq_u32_sdwa s[74:75], v45, v25 src0_sel:WORD_1 src1_sel:DWORD
  v_and_b32 v45, 0xffff, v45
  s_mov_b64 exec, s[74:75]
  ds_add_rtn_u32 v108, v45, v24 offset:57600
  s_cmp_le_u32 s43, 1
  s_cbranch_scc1 K2_AX
  s_mov_b64 exec, s[76:77]
  v_cmp_eq_u32_sdwa s[76:77], v47, v25 src0_sel:WORD_1 src1_sel:DWORD
  v_and_b32 v47, 0xffff, v47
  s_mov_b64 exec, s[76:77]
  ds_add_rtn_u32 v109, v47, v24 offset:57600
  s_cmp_le_u32 s43, 2
  s_cbranch_scc1 K2_AX
  s_mov_b64 exec, s[78:79]
  v_cmp_eq_u32_sdwa s[78:79], v49, v25 src0_sel:WORD_1 src1_sel:DWORD
  v_and_b32 v49, 0xffff, v49
  s_mov_b64 exec, s[78:79]
  ds_add_rtn_u32 v110, v49, v24 offset:57600
  s_cmp_le_u32 s43, 3
  s_cbranch_scc1 K2_AX
  s_mov_b64 exec, s[80:81]
  v_cmp_eq_u32_sdwa s[80:81], v51, v25 src0_sel:WORD_1 src1_sel:DWORD
  v_and_b32 v51, 0xffff, v51
  s_mov_b64 exec, s[80:81]
  ds_add_rtn_u32 v111, v51, v24 offset:57600
  s_cmp_le_u32 s43, 4
  s_cbranch_scc1 K2_AX
  s_mov_b64 exec, s[82:83]
  v_cmp_eq_u32_sdwa s[82:83], v53, v25 src0_sel:WORD_1 src1_sel:DWORD
  v_and_b32 v53, 0xffff, v53
  s_mov_b64 exec, s[82:83]
  ds_add_rtn_u32 v112, v53, v24 offset:57600
  s_cmp_le_u32 s43, 5
  s_cbranch_scc1 K2_AX
  s_mov_b64 exec, s[84:85]
  v_cmp_eq_u32_sdwa s[84:85], v55, v25 src0_sel:WORD_1 src1_sel:DWORD
  v_and_b32 v55, 0xffff, v55
  s_mov_b64 exec, s[84:85]
  ds_add_rtn_u32 v113, v55, v24 offset:57600
  s_cmp_le_u32 s43, 6
  s_cbranch_scc1 K2_AX
  s_mov_b64 exec, s[86:87]
  v_cmp_eq_u32_sdwa s[86:87], v57, v25 src0_sel:WORD_1 src1_sel:DWORD
  v_and_b32 v57, 0xffff, v57
  s_mov_b64 exec, s[86:87]
  ds_add_rtn_u32 v114, v57, v24 offset:57600
  s_cmp_le_u32 s43, 7
  s_cbranch_scc1 K2_AX
  s_mov_b64 exec, s[88:89]
  v_cmp_eq_u32_sdwa s[88:89], v59, v25 src0_sel:WORD_1 src1_sel:DWORD
  v_and_b32 v59, 0xffff, v59
  s_mov_b64 exec, s[88:89]
  ds_add_rtn_u32 v115, v59, v24 offset:57600
K2_AX:
  s_waitcnt lgkmcnt(0)
  s_mov_b64 exec, s[58:59]
  ds_write_b32 v100, v28
  s_mov_b64 exec, s[60:61]
  ds_write_b32 v101, v29
  s_mov_b64 exec, s[62:63]
  ds_write_b32 v102, v32
  s_mov_b64 exec, s[64:65]
  ds_write_b32 v103, v33
  s_mov_b64 exec, s[66:67]
  ds_write_b32 v104, v36
  s_mov_b64 exec, s[68:69]
  ds_write_b32 v105, v37
  s_mov_b64 exec, s[70:71]
  ds_write_b32 v106, v40
  s_mov_b64 exec, s[72:73]
  ds_write_b32 v107, v41
  s_cmp_le_u32 s43, 0
  s_cbranch_scc1 K2_BX
  s_mov_b64 exec, s[74:75]
  ds_write_b32 v108, v44
  s_cmp_le_u32 s43, 1
  s_cbranch_scc1 K2_BX
  s_mov_b64 exec, s[76:77]
  ds_write_b32 v109, v46
  s_cmp_le_u32 s43, 2
  s_cbranch_scc1 K2_BX
  s_mov_b64 exec, s[78:79]
  ds_write_b32 v110, v48
  s_cmp_le_u32 s43, 3
  s_cbranch_scc1 K2_BX
  s_mov_b64 exec, s[80:81]
  ds_write_b32 v111, v50
  s_cmp_le_u32 s43, 4
  s_cbranch_scc1 K2_BX
  s_mov_b64 exec, s[82:83]
  ds_write_b32 v112, v52
  s_cmp_le_u32 s43, 5
  s_cbranch_scc1 K2_BX
  s_mov_b64 exec, s[84:85]
  ds_write_b32 v113, v54
  s_cmp_le_u32 s43, 6
  s_cbranch_scc1 K2_BX
  s_mov_b64 exec, s[86:87]
  ds_write_b32 v114, v56
  s_cmp_le_u32 s43, 7
  s_cbranch_scc1 K2_BX
  s_mov_b64 exec, s[88:89]
  ds_write_b32 v115, v58
K2_BX:
  s_mov_b64 exec, -1
  s_cmp_lt_u32 s36, 7
  s_cbranch_scc0 K2_NOPRE
  v_lshlrev_b32 v117, 3, v3
  v_bfe_u32 v9, v1, 2, 2
  v_add_u32 v117, v117, v9
  v_lshlrev_b32 v117, 6, v117
  v_bfe_u32 v9, v1, 4, 1
  v_lshl_add_u32 v117, v9, 5, v117
  v_and_b32 v9, 3, v1
  v_lshl_add_u32 v117, v9, 3, v117
  v_add_u32 v117, 131072, v117
  s_mul_i32 s3, s36, 4608
  s_movk_i32 s40, 144
  v_and_b32 v9, 31, v1
  v_lshl_add_u32 v118, v3, 4, s3
  v_mad_u32_u24 v118, v9, s40, v118
  v_lshrrev_b32 v119, 3, v1
  v_and_b32 v9, 7, v1
  v_lshlrev_b32 v9, 4, v9
  v_mad_u32_u24 v119, v119, s40, v9
  v_add_u32 v119, s3, v119
K2_NOPRE:
  s_waitcnt lgkmcnt(0)
  s_barrier
  s_cmp_ge_u32 s35, 4
  s_cbranch_scc1 K2_MM
  v_cmp_gt_u32 vcc, 200, v0
  s_and_saveexec_b64 s[56:57], vcc
  v_lshlrev_b32 v8, 2, v0
  ds_read_b32 v9, v8 offset:57600
  s_movk_i32 s3, 324
  v_mov_b32 v13, 65536
  v_mad_u32_u24 v13, v0, s3, v13
  v_mov_b32 v11, 1
  s_waitcnt lgkmcnt(0)
  v_sub_u32 v9, v9, v13
  v_lshrrev_b32 v9, 2, v9
  v_cmp_lt_u32 vcc, 80, v9
  v_min_u32 v9, 127, v9
  v_lshlrev_b32 v10, 2, v9
  ds_add_rtn_u32 v12, v10, v11 offset:58624
  s_cbranch_vccz K2_S0A
  v_mov_b32 v14, 61376
  ds_write_b32 v14, v11
K2_S0A:
  s_mov_b64 exec, s[56:57]
  s_waitcnt lgkmcnt(0)
  v_mov_b32 v14, 61384
  s_mov_b64 exec, 1
  ds_add_u32 v14, v11
  s_mov_b64 exec, -1
K2_S0W:
  ds_read_b32 v15, v14
  s_waitcnt lgkmcnt(0)
  v_readfirstlane_b32 s3, v15
  s_nop 0
  s_cmp_lt_u32 s3, 4
  s_cbranch_scc1 K2_S0W
  v_lshlrev_b32 v14, 3, v1
  v_sub_u32 v14, 504, v14
  ds_read_b64 v[16:17], v14 offset:58624
  s_waitcnt lgkmcnt(0)
  v_add_u32 v18, v16, v17
  s_nop 1
  v_add_u32_dpp v18, v18, v18 row_shr:1 row_mask:0xf bank_mask:0xf
  s_nop 1
  v_add_u32_dpp v18, v18, v18 row_shr:2 row_mask:0xf bank_mask:0xf
  s_nop 1
  v_add_u32_dpp v18, v18, v18 row_shr:4 row_mask:0xf bank_mask:0xf
  s_nop 1
  v_add_u32_dpp v18, v18, v18 row_shr:8 row_mask:0xf bank_mask:0xf
  s_nop 1
  v_add_u32_dpp v18, v18, v18 row_bcast:15 row_mask:0xa bank_mask:0xf
  s_nop 1
  v_add_u32_dpp v18, v18, v18 row_bcast:31 row_mask:0xc bank_mask:0xf
  s_nop 1
  v_sub_u32 v20, v18, v16
  v_sub_u32 v21, v20, v17
  ds_write_b64 v14, v[20:21] offset:59136
  v_cmp_gt_u32 vcc, 200, v0
  s_and_saveexec_b64 s[56:57], vcc
  ds_read_b32 v14, v10 offset:59136
  s_movk_i32 s3, 144
  v_mul_u32_u24 v15, s3, v0
  v_lshl_or_b32 v15, v9, 16, v15
  v_lshl_or_b32 v15, v0, 23, v15
  v_mov_b32 v16, v13
  v_mov_b32 v17, v15
  s_waitcnt lgkmcnt(0)
  v_add_lshl_u32 v14, v14, v12, 3
  ds_write_b64 v14, v[16:17] offset:59648
  s_mov_b64 exec, s[56:57]
  s_waitcnt lgkmcnt(0)
  s_branch K2_S1
K2_MM:
  s_cmp_lt_u32 s36, 7
  s_cbranch_scc1 K2_MM1
  s_lshr_b32 s3, s2, 3
  s_mul_i32 s3, s3, 100352
  s_mul_i32 s40, s34, 3211264
  s_add_u32 s3, s3, s40
  s_sub_u32 s40, s36, 7
  s_mul_i32 s40, s40, 8192
  s_add_u32 s3, s3, s40
  s_add_u32 s3, s3, 6553600
  v_lshlrev_b32 v120, 7, v1
  buffer_load_dword v116, v120, s[16:19], s3 offen
  s_branch K2_S1
K2_MM1:
  ds_read_b64_tr_b16 v[80:81], v117 offset:0
  ds_read_b64_tr_b16 v[82:83], v117 offset:256
  ds_read_b64_tr_b16 v[84:85], v117 offset:1024
  ds_read_b64_tr_b16 v[86:87], v117 offset:1280
  ds_read_b64_tr_b16 v[88:89], v117 offset:2048
  ds_read_b64_tr_b16 v[90:91], v117 offset:2304
  ds_read_b64_tr_b16 v[92:93], v117 offset:3072
  ds_read_b64_tr_b16 v[94:95], v117 offset:3328
  ds_read_b64_tr_b16 v[100:101], v117 offset:4096
  ds_read_b64_tr_b16 v[102:103], v117 offset:4352
  ds_read_b64_tr_b16 v[104:105], v117 offset:5120
  ds_read_b64_tr_b16 v[106:107], v117 offset:5376
  ds_read_b64_tr_b16 v[108:109], v117 offset:6144
  ds_read_b64_tr_b16 v[110:111], v117 offset:6400
  ds_read_b64_tr_b16 v[112:113], v117 offset:7168
  ds_read_b64_tr_b16 v[114:115], v117 offset:7424
  s_cmp_eq_u32 s36, 6
  s_cselect_b32 s40, 0xff, -1
  s_cselect_b32 s41, 0xff, -1
  s_mov_b32 s42, 0xbfb8aa3b
  s_waitcnt vmcnt(0) lgkmcnt(8)
  v_mfma_f32_32x32x16_bf16 v[8:23], v[80:83], v[64:67], 0
  v_mfma_f32_32x32x16_bf16 v[8:23], v[84:87], v[68:71], v[8:23]
  v_mfma_f32_32x32x16_bf16 v[8:23], v[88:91], v[72:75], v[8:23]
  v_mfma_f32_32x32x16_bf16 v[8:23], v[92:95], v[76:79], v[8:23]
  s_waitcnt lgkmcnt(0)
  v_mfma_f32_32x32x16_bf16 v[28:43], v[100:103], v[64:67], 0
  v_mfma_f32_32x32x16_bf16 v[28:43], v[104:107], v[68:71], v[28:43]
  v_mfma_f32_32x32x16_bf16 v[28:43], v[108:111], v[72:75], v[28:43]
  v_mfma_f32_32x32x16_bf16 v[28:43], v[112:115], v[76:79], v[28:43]
  s_nop 7
  v_pk_mul_f32 v[8:9], v[8:9], s[42:43] op_sel_hi:[1,0]
  v_pk_mul_f32 v[10:11], v[10:11], s[42:43] op_sel_hi:[1,0]
  v_pk_mul_f32 v[12:13], v[12:13], s[42:43] op_sel_hi:[1,0]
  v_pk_mul_f32 v[14:15], v[14:15], s[42:43] op_sel_hi:[1,0]
  v_pk_mul_f32 v[16:17], v[16:17], s[42:43] op_sel_hi:[1,0]
  v_pk_mul_f32 v[18:19], v[18:19], s[42:43] op_sel_hi:[1,0]
  v_pk_mul_f32 v[20:21], v[20:21], s[42:43] op_sel_hi:[1,0]
  v_pk_mul_f32 v[22:23], v[22:23], s[42:43] op_sel_hi:[1,0]
  v_max3_f32 v26, v8, v9, v10
  v_max3_f32 v26, v11, v12, v26
  v_max3_f32 v26, v13, v14, v26
  v_max3_f32 v26, v15, v16, v26
  v_max3_f32 v26, v17, v18, v26
  v_max3_f32 v26, v19, v20, v26
  v_max3_f32 v26, v21, v22, v26
  v_max_f32 v26, v23, v26
  v_mov_b32 v27, 0x41a00000
  v_cmp_nle_f32 vcc, v26, v27
  s_and_b64 vcc, vcc, s[40:41]
  s_cbranch_vccz K2_POK
  v_mov_b32 v26, 1
  v_mov_b32 v27, 61376
  ds_write_b32 v27, v26
K2_POK:
  s_mov_b64 exec, s[40:41]
  ds_write_b128 v118, v[8:11] offset:0
  ds_write_b128 v118, v[12:15] offset:32
  ds_write_b128 v118, v[16:19] offset:64
  ds_write_b128 v118, v[20:23] offset:96
  ds_write_b128 v118, v[28:31] offset:28800
  ds_write_b128 v118, v[32:35] offset:28832
  ds_write_b128 v118, v[36:39] offset:28864
  ds_write_b128 v118, v[40:43] offset:28896
  s_mov_b64 exec, -1
  s_waitcnt lgkmcnt(0)
K2_S1:
  s_setprio 3
  s_barrier
  v_lshlrev_b32 v8, 6, v1
  v_min_u32 v8, 1536, v8
  ds_read_b32 v9, v8 offset:59652
  v_mov_b32 v10, 0
  ds_read_b32 v11, v10 offset:61376
  v_and_b32 v61, 7, v1
  v_lshlrev_b32 v61, 4, v61
  ds_read_b128 v[4:7], v61 offset:61248
  v_cmp_gt_u32 vcc, 25, v1
  v_lshrrev_b32 v62, 3, v1
  v_lshlrev_b32 v62, 3, v62
  v_mov_b32 v17, v61
  v_mov_b32 v19, v61
  v_mov_b32 v21, v61
  v_mov_b32 v23, v61
  s_waitcnt lgkmcnt(1)
  v_bfe_u32 v9, v9, 16, 7
  v_readfirstlane_b32 s3, v11
  v_add_u32 v9, 1, v9
  v_lshrrev_b32 v9, 1, v9
  v_cndmask_b32 v9, 0, v9, vcc
  v_mov_b32 v60, v9
  s_cmp_lg_u32 s3, 0
  s_cbranch_scc1 K2_SLOW
  s_nop 1
  v_add_u32_dpp v60, v60, v60 row_shr:1 row_mask:0xf bank_mask:0xf
  s_nop 1
  v_add_u32_dpp v60, v60, v60 row_shr:2 row_mask:0xf bank_mask:0xf
  s_nop 1
  v_add_u32_dpp v60, v60, v60 row_shr:4 row_mask:0xf bank_mask:0xf
  s_nop 1
  v_add_u32_dpp v60, v60, v60 row_shr:8 row_mask:0xf bank_mask:0xf
  s_nop 1
  v_add_u32_dpp v60, v60, v60 row_bcast:15 row_mask:0xa bank_mask:0xf
  s_add_u32 s3, s35, 1
  v_readlane_b32 s58, v60, 31
  v_sub_u32 v60, v60, v9
  s_mul_i32 s59, s58, s35
  s_mul_i32 s60, s58, s3
  s_lshr_b32 s59, s59, 4
  s_lshr_b32 s60, s60, 4
K2_SEG:
  s_cmp_ge_u32 s59, s60
  s_cbranch_scc1 K2_DONE
  s_setprio 3
  v_cmp_ge_u32 vcc, s59, v60
  s_bcnt1_i32_b32 s61, vcc_lo
  s_sub_u32 s61, s61, 1
  s_add_u32 s62, s61, 1
  v_readlane_b32 s63, v60, s61
  v_readlane_b32 s64, v60, s62
  s_lshl_b32 s3, s61, 6
  v_add_u32 v8, s3, v62
  ds_read_b64 v[80:81], v8 offset:59648
  s_min_u32 s64, s64, s60
  s_sub_u32 s65, s64, s59
  s_sub_u32 s66, s59, s63
  s_sub_u32 s84, s60, s59
  s_mov_b32 s59, s64
  s_mul_i32 s66, s66, 8
  s_waitcnt lgkmcnt(0)
  v_add_u32 v80, s66, v80
  v_add_u32_sdwa v81, v81, v61 dst_sel:DWORD dst_unused:UNUSED_PAD src0_sel:WORD_0 src1_sel:DWORD
  s_cmp_eq_u32 s66, 0
  s_nop 0
  ds_read_u16 v16, v80 offset:0
  ds_read_u16 v18, v80 offset:4
  ds_read_u16 v20, v80 offset:8
  ds_read_u16 v22, v80 offset:12
  ds_read_b128 v[8:11], v81 offset:0
  s_cbranch_scc1 K2_PRIM
  v_mov_b32 v12, 0
  v_mov_b32 v13, 0
  v_mov_b32 v14, 0
  v_mov_b32 v15, 0
  s_mov_b32 s80, 1
  s_waitcnt lgkmcnt(1)
  s_branch K2_PRIM2
K2_PRIM:
  ds_read_b128 v[12:15], v81 offset:28800
  s_mov_b32 s80, 0
  s_waitcnt lgkmcnt(2)
K2_PRIM2:
  buffer_load_dwordx4 v[36:39], v[16:17], s[24:27], 0 idxen offen
  buffer_load_dwordx4 v[40:43], v[18:19], s[24:27], 0 idxen offen
  buffer_load_dwordx4 v[44:47], v[20:21], s[24:27], 0 idxen offen
  buffer_load_dwordx4 v[48:51], v[22:23], s[24:27], 0 idxen offen
  ds_read_u16_d16_hi v24, v80 offset:2
  ds_read_u16_d16_hi v25, v80 offset:6
  ds_read_u16_d16_hi v26, v80 offset:10
  ds_read_u16_d16_hi v27, v80 offset:14
  s_cmp_gt_u32 s84, 10
  s_cbranch_scc0 K2_PL1
  s_setprio 2
  s_sub_u32 s84, s84, 10
  s_mov_b32 s85, 2
  s_branch K2_PLD
K2_PL1:
  s_cmp_gt_u32 s84, 4
  s_cbranch_scc0 K2_PL0
  s_setprio 1
  s_sub_u32 s84, s84, 4
  s_mov_b32 s85, 1
  s_branch K2_PLD
K2_PL0:
  s_setprio 0
  s_movk_i32 s84, 0x7fff
K2_PLD:
  s_waitcnt lgkmcnt(0)
  s_cmp_le_u32 s65, 2
  s_cbranch_scc1 K2_TS
  s_sub_u32 s65, s65, 2
  s_cmp_lt_u32 s65, 2
  s_cbranch_scc1 K2_CHK
K2_RING:
  s_waitcnt vmcnt(2)
  v_pk_fma_f32 v[64:65], v[24:25], v[4:5], v[8:9] op_sel_hi:[0,1,1]
  v_pk_fma_f32 v[66:67], v[24:25], v[6:7], v[10:11] op_sel_hi:[0,1,1]
  v_pk_fma_f32 v[68:69], v[24:25], v[4:5], v[8:9] op_sel:[1,0,0] op_sel_hi:[1,1,1]
  v_pk_fma_f32 v[70:71], v[24:25], v[6:7], v[10:11] op_sel:[1,0,0] op_sel_hi:[1,1,1]
  ds_read_u16 v16, v80 offset:16
  ds_read_u16 v18, v80 offset:20
  v_exp_f32 v64, v64
  v_exp_f32 v65, v65
  v_exp_f32 v66, v66
  v_exp_f32 v67, v67
  v_exp_f32 v68, v68
  v_exp_f32 v69, v69
  v_exp_f32 v70, v70
  v_exp_f32 v71, v71
  ds_read_u16_d16_hi v24, v80 offset:18
  ds_read_u16_d16_hi v25, v80 offset:22
  v_fma_mix_f32 v64, v36, v64, 1.0 op_sel_hi:[1,0,0]
  v_fma_mix_f32 v65, v37, v65, 1.0 op_sel_hi:[1,0,0]
  v_fma_mix_f32 v66, v38, v66, 1.0 op_sel_hi:[1,0,0]
  v_fma_mix_f32 v67, v39, v67, 1.0 op_sel_hi:[1,0,0]
  v_fma_mix_f32 v68, v40, v68, 1.0 op_sel_hi:[1,0,0]
  v_fma_mix_f32 v69, v41, v69, 1.0 op_sel_hi:[1,0,0]
  v_fma_mix_f32 v70, v42, v70, 1.0 op_sel_hi:[1,0,0]
  v_fma_mix_f32 v71, v43, v71, 1.0 op_sel_hi:[1,0,0]
  v_pk_mul_f32 v[76:77], v[64:65], v[68:69]
  v_pk_mul_f32 v[78:79], v[66:67], v[70:71]
  v_pk_mul_f32 v[72:73], v[36:37], v[68:69]
  v_pk_mul_f32 v[74:75], v[38:39], v[70:71]
  v_rcp_f32 v76, v76
  v_rcp_f32 v77, v77
  v_rcp_f32 v78, v78
  v_rcp_f32 v79, v79
  v_pk_fma_f32 v[72:73], v[40:41], v[64:65], v[72:73]
  v_pk_fma_f32 v[74:75], v[42:43], v[66:67], v[74:75]
  v_pk_fma_f32 v[12:13], v[72:73], v[76:77], v[12:13]
  v_pk_fma_f32 v[14:15], v[74:75], v[78:79], v[14:15]
  s_waitcnt lgkmcnt(2)
  buffer_load_dwordx4 v[36:39], v[16:17], s[24:27], 0 idxen offen
  buffer_load_dwordx4 v[40:43], v[18:19], s[24:27], 0 idxen offen
  s_waitcnt vmcnt(2)
  v_pk_fma_f32 v[64:65], v[26:27], v[4:5], v[8:9] op_sel_hi:[0,1,1]
  v_pk_fma_f32 v[66:67], v[26:27], v[6:7], v[10:11] op_sel_hi:[0,1,1]
  v_pk_fma_f32 v[68:69], v[26:27], v[4:5], v[8:9] op_sel:[1,0,0] op_sel_hi:[1,1,1]
  v_pk_fma_f32 v[70:71], v[26:27], v[6:7], v[10:11] op_sel:[1,0,0] op_sel_hi:[1,1,1]
  ds_read_u16 v20, v80 offset:24
  ds_read_u16 v22, v80 offset:28
  v_exp_f32 v64, v64
  v_exp_f32 v65, v65
  v_exp_f32 v66, v66
  v_exp_f32 v67, v67
  v_exp_f32 v68, v68
  v_exp_f32 v69, v69
  v_exp_f32 v70, v70
  v_exp_f32 v71, v71
  ds_read_u16_d16_hi v26, v80 offset:26
  ds_read_u16_d16_hi v27, v80 offset:30
  v_fma_mix_f32 v64, v44, v64, 1.0 op_sel_hi:[1,0,0]
  v_fma_mix_f32 v65, v45, v65, 1.0 op_sel_hi:[1,0,0]
  v_fma_mix_f32 v66, v46, v66, 1.0 op_sel_hi:[1,0,0]
  v_fma_mix_f32 v67, v47, v67, 1.0 op_sel_hi:[1,0,0]
  v_fma_mix_f32 v68, v48, v68, 1.0 op_sel_hi:[1,0,0]
  v_fma_mix_f32 v69, v49, v69, 1.0 op_sel_hi:[1,0,0]
  v_fma_mix_f32 v70, v50, v70, 1.0 op_sel_hi:[1,0,0]
  v_fma_mix_f32 v71, v51, v71, 1.0 op_sel_hi:[1,0,0]
  v_pk_mul_f32 v[76:77], v[64:65], v[68:69]
  v_pk_mul_f32 v[78:79], v[66:67], v[70:71]
  v_pk_mul_f32 v[72:73], v[44:45], v[68:69]
  v_pk_mul_f32 v[74:75], v[46:47], v[70:71]
  v_rcp_f32 v76, v76
  v_rcp_f32 v77, v77
  v_rcp_f32 v78, v78
  v_rcp_f32 v79, v79
  v_pk_fma_f32 v[72:73], v[48:49], v[64:65], v[72:73]
  v_pk_fma_f32 v[74:75], v[50:51], v[66:67], v[74:75]
  v_pk_fma_f32 v[12:13], v[72:73], v[76:77], v[12:13]
  v_pk_fma_f32 v[14:15], v[74:75], v[78:79], v[14:15]
  s_waitcnt lgkmcnt(2)
  buffer_load_dwordx4 v[44:47], v[20:21], s[24:27], 0 idxen offen
  buffer_load_dwordx4 v[48:51], v[22:23], s[24:27], 0 idxen offen
  v_add_u32 v80, 16, v80
  s_sub_u32 s84, s84, 2
  s_cbranch_scc1 K2_PRIO
K2_PRIOR:
  s_sub_u32 s65, s65, 2
  s_cmp_ge_u32 s65, 2
  s_cbranch_scc1 K2_RING
K2_CHK:
  s_cmp_eq_u32 s65, 0
  s_cbranch_scc1 K2_T0
  s_waitcnt vmcnt(2)
  v_pk_fma_f32 v[64:65], v[24:25], v[4:5], v[8:9] op_sel_hi:[0,1,1]
  v_pk_fma_f32 v[66:67], v[24:25], v[6:7], v[10:11] op_sel_hi:[0,1,1]
  v_pk_fma_f32 v[68:69], v[24:25], v[4:5], v[8:9] op_sel:[1,0,0] op_sel_hi:[1,1,1]
  v_pk_fma_f32 v[70:71], v[24:25], v[6:7], v[10:11] op_sel:[1,0,0] op_sel_hi:[1,1,1]
  ds_read_u16 v16, v80 offset:16
  ds_read_u16 v18, v80 offset:20
  v_exp_f32 v64, v64
  v_exp_f32 v65, v65
  v_exp_f32 v66, v66
  v_exp_f32 v67, v67
  v_exp_f32 v68, v68
  v_exp_f32 v69, v69
  v_exp_f32 v70, v70
  v_exp_f32 v71, v71
  ds_read_u16_d16_hi v24, v80 offset:18
  ds_read_u16_d16_hi v25, v80 offset:22
  v_fma_mix_f32 v64, v36, v64, 1.0 op_sel_hi:[1,0,0]
  v_fma_mix_f32 v65, v37, v65, 1.0 op_sel_hi:[1,0,0]
  v_fma_mix_f32 v66, v38, v66, 1.0 op_sel_hi:[1,0,0]
  v_fma_mix_f32 v67, v39, v67, 1.0 op_sel_hi:[1,0,0]
  v_fma_mix_f32 v68, v40, v68, 1.0 op_sel_hi:[1,0,0]
  v_fma_mix_f32 v69, v41, v69, 1.0 op_sel_hi:[1,0,0]
  v_fma_mix_f32 v70, v42, v70, 1.0 op_sel_hi:[1,0,0]
  v_fma_mix_f32 v71, v43, v71, 1.0 op_sel_hi:[1,0,0]
  v_pk_mul_f32 v[76:77], v[64:65], v[68:69]
  v_pk_mul_f32 v[78:79], v[66:67], v[70:71]
  v_pk_mul_f32 v[72:73], v[36:37], v[68:69]
  v_pk_mul_f32 v[74:75], v[38:39], v[70:71]
  v_rcp_f32 v76, v76
  v_rcp_f32 v77, v77
  v_rcp_f32 v78, v78
  v_rcp_f32 v79, v79
  v_pk_fma_f32 v[72:73], v[40:41], v[64:65], v[72:73]
  v_pk_fma_f32 v[74:75], v[42:43], v[66:67], v[74:75]
  v_pk_fma_f32 v[12:13], v[72:73], v[76:77], v[12:13]
  v_pk_fma_f32 v[14:15], v[74:75], v[78:79], v[14:15]
  s_waitcnt lgkmcnt(2)
  buffer_load_dwordx4 v[36:39], v[16:17], s[24:27], 0 idxen offen
  buffer_load_dwordx4 v[40:43], v[18:19], s[24:27], 0 idxen offen
K2_T1:
  s_waitcnt lgkmcnt(0)
  s_waitcnt vmcnt(2)
  v_pk_fma_f32 v[64:65], v[26:27], v[4:5], v[8:9] op_sel_hi:[0,1,1]
  v_pk_fma_f32 v[66:67], v[26:27], v[6:7], v[10:11] op_sel_hi:[0,1,1]
  v_pk_fma_f32 v[68:69], v[26:27], v[4:5], v[8:9] op_sel:[1,0,0] op_sel_hi:[1,1,1]
  v_pk_fma_f32 v[70:71], v[26:27], v[6:7], v[10:11] op_sel:[1,0,0] op_sel_hi:[1,1,1]
  v_exp_f32 v64, v64
  v_exp_f32 v65, v65
  v_exp_f32 v66, v66
  v_exp_f32 v67, v67
  v_exp_f32 v68, v68
  v_exp_f32 v69, v69
  v_exp_f32 v70, v70
  v_exp_f32 v71, v71
  v_fma_mix_f32 v64, v44, v64, 1.0 op_sel_hi:[1,0,0]
  v_fma_mix_f32 v65, v45, v65, 1.0 op_sel_hi:[1,0,0]
  v_fma_mix_f32 v66, v46, v66, 1.0 op_sel_hi:[1,0,0]
  v_fma_mix_f32 v67, v47, v67, 1.0 op_sel_hi:[1,0,0]
  v_fma_mix_f32 v68, v48, v68, 1.0 op_sel_hi:[1,0,0]
  v_fma_mix_f32 v69, v49, v69, 1.0 op_sel_hi:[1,0,0]
  v_fma_mix_f32 v70, v50, v70, 1.0 op_sel_hi:[1,0,0]
  v_fma_mix_f32 v71, v51, v71, 1.0 op_sel_hi:[1,0,0]
  v_pk_mul_f32 v[76:77], v[64:65], v[68:69]
  v_pk_mul_f32 v[78:79], v[66:67], v[70:71]
  v_pk_mul_f32 v[72:73], v[44:45], v[68:69]
  v_pk_mul_f32 v[74:75], v[46:47], v[70:71]
  v_rcp_f32 v76, v76
  v_rcp_f32 v77, v77
  v_rcp_f32 v78, v78
  v_rcp_f32 v79, v79
  v_pk_fma_f32 v[72:73], v[48:49], v[64:65], v[72:73]
  v_pk_fma_f32 v[74:75], v[50:51], v[66:67], v[74:75]
  v_pk_fma_f32 v[12:13], v[72:73], v[76:77], v[12:13]
  v_pk_fma_f32 v[14:15], v[74:75], v[78:79], v[14:15]
  s_waitcnt vmcnt(0)
  v_pk_fma_f32 v[64:65], v[24:25], v[4:5], v[8:9] op_sel_hi:[0,1,1]
  v_pk_fma_f32 v[66:67], v[24:25], v[6:7], v[10:11] op_sel_hi:[0,1,1]
  v_pk_fma_f32 v[68:69], v[24:25], v[4:5], v[8:9] op_sel:[1,0,0] op_sel_hi:[1,1,1]
  v_pk_fma_f32 v[70:71], v[24:25], v[6:7], v[10:11] op_sel:[1,0,0] op_sel_hi:[1,1,1]
  v_exp_f32 v64, v64
  v_exp_f32 v65, v65
  v_exp_f32 v66, v66
  v_exp_f32 v67, v67
  v_exp_f32 v68, v68
  v_exp_f32 v69, v69
  v_exp_f32 v70, v70
  v_exp_f32 v71, v71
  v_fma_mix_f32 v64, v36, v64, 1.0 op_sel_hi:[1,0,0]
  v_fma_mix_f32 v65, v37, v65, 1.0 op_sel_hi:[1,0,0]
  v_fma_mix_f32 v66, v38, v66, 1.0 op_sel_hi:[1,0,0]
  v_fma_mix_f32 v67, v39, v67, 1.0 op_sel_hi:[1,0,0]
  v_fma_mix_f32 v68, v40, v68, 1.0 op_sel_hi:[1,0,0]
  v_fma_mix_f32 v69, v41, v69, 1.0 op_sel_hi:[1,0,0]
  v_fma_mix_f32 v70, v42, v70, 1.0 op_sel_hi:[1,0,0]
  v_fma_mix_f32 v71, v43, v71, 1.0 op_sel_hi:[1,0,0]
  v_pk_mul_f32 v[76:77], v[64:65], v[68:69]
  v_pk_mul_f32 v[78:79], v[66:67], v[70:71]
  v_pk_mul_f32 v[72:73], v[36:37], v[68:69]
  v_pk_mul_f32 v[74:75], v[38:39], v[70:71]
  v_rcp_f32 v76, v76
  v_rcp_f32 v77, v77
  v_rcp_f32 v78, v78
  v_rcp_f32 v79, v79
  v_pk_fma_f32 v[72:73], v[40:41], v[64:65], v[72:73]
  v_pk_fma_f32 v[74:75], v[42:43], v[66:67], v[74:75]
  v_pk_fma_f32 v[12:13], v[72:73], v[76:77], v[12:13]
  v_pk_fma_f32 v[14:15], v[74:75], v[78:79], v[14:15]
  s_branch K2_FLUSH
K2_T0:
  s_waitcnt lgkmcnt(0)
  s_waitcnt vmcnt(2)
  v_pk_fma_f32 v[64:65], v[24:25], v[4:5], v[8:9] op_sel_hi:[0,1,1]
  v_pk_fma_f32 v[66:67], v[24:25], v[6:7], v[10:11] op_sel_hi:[0,1,1]
  v_pk_fma_f32 v[68:69], v[24:25], v[4:5], v[8:9] op_sel:[1,0,0] op_sel_hi:[1,1,1]
  v_pk_fma_f32 v[70:71], v[24:25], v[6:7], v[10:11] op_sel:[1,0,0] op_sel_hi:[1,1,1]
  v_exp_f32 v64, v64
  v_exp_f32 v65, v65
  v_exp_f32 v66, v66
  v_exp_f32 v67, v67
  v_exp_f32 v68, v68
  v_exp_f32 v69, v69
  v_exp_f32 v70, v70
  v_exp_f32 v71, v71
  v_fma_mix_f32 v64, v36, v64, 1.0 op_sel_hi:[1,0,0]
  v_fma_mix_f32 v65, v37, v65, 1.0 op_sel_hi:[1,0,0]
  v_fma_mix_f32 v66, v38, v66, 1.0 op_sel_hi:[1,0,0]
  v_fma_mix_f32 v67, v39, v67, 1.0 op_sel_hi:[1,0,0]
  v_fma_mix_f32 v68, v40, v68, 1.0 op_sel_hi:[1,0,0]
  v_fma_mix_f32 v69, v41, v69, 1.0 op_sel_hi:[1,0,0]
  v_fma_mix_f32 v70, v42, v70, 1.0 op_sel_hi:[1,0,0]
  v_fma_mix_f32 v71, v43, v71, 1.0 op_sel_hi:[1,0,0]
  v_pk_mul_f32 v[76:77], v[64:65], v[68:69]
  v_pk_mul_f32 v[78:79], v[66:67], v[70:71]
  v_pk_mul_f32 v[72:73], v[36:37], v[68:69]
  v_pk_mul_f32 v[74:75], v[38:39], v[70:71]
  v_rcp_f32 v76, v76
  v_rcp_f32 v77, v77
  v_rcp_f32 v78, v78
  v_rcp_f32 v79, v79
  v_pk_fma_f32 v[72:73], v[40:41], v[64:65], v[72:73]
  v_pk_fma_f32 v[74:75], v[42:43], v[66:67], v[74:75]
  v_pk_fma_f32 v[12:13], v[72:73], v[76:77], v[12:13]
  v_pk_fma_f32 v[14:15], v[74:75], v[78:79], v[14:15]
  s_waitcnt vmcnt(0)
  v_pk_fma_f32 v[64:65], v[26:27], v[4:5], v[8:9] op_sel_hi:[0,1,1]
  v_pk_fma_f32 v[66:67], v[26:27], v[6:7], v[10:11] op_sel_hi:[0,1,1]
  v_pk_fma_f32 v[68:69], v[26:27], v[4:5], v[8:9] op_sel:[1,0,0] op_sel_hi:[1,1,1]
  v_pk_fma_f32 v[70:71], v[26:27], v[6:7], v[10:11] op_sel:[1,0,0] op_sel_hi:[1,1,1]
  v_exp_f32 v64, v64
  v_exp_f32 v65, v65
  v_exp_f32 v66, v66
  v_exp_f32 v67, v67
  v_exp_f32 v68, v68
  v_exp_f32 v69, v69
  v_exp_f32 v70, v70
  v_exp_f32 v71, v71
  v_fma_mix_f32 v64, v44, v64, 1.0 op_sel_hi:[1,0,0]
  v_fma_mix_f32 v65, v45, v65, 1.0 op_sel_hi:[1,0,0]
  v_fma_mix_f32 v66, v46, v66, 1.0 op_sel_hi:[1,0,0]
  v_fma_mix_f32 v67, v47, v67, 1.0 op_sel_hi:[1,0,0]
  v_fma_mix_f32 v68, v48, v68, 1.0 op_sel_hi:[1,0,0]
  v_fma_mix_f32 v69, v49, v69, 1.0 op_sel_hi:[1,0,0]
  v_fma_mix_f32 v70, v50, v70, 1.0 op_sel_hi:[1,0,0]
  v_fma_mix_f32 v71, v51, v71, 1.0 op_sel_hi:[1,0,0]
  v_pk_mul_f32 v[76:77], v[64:65], v[68:69]
  v_pk_mul_f32 v[78:79], v[66:67], v[70:71]
  v_pk_mul_f32 v[72:73], v[44:45], v[68:69]
  v_pk_mul_f32 v[74:75], v[46:47], v[70:71]
  v_rcp_f32 v76, v76
  v_rcp_f32 v77, v77
  v_rcp_f32 v78, v78
  v_rcp_f32 v79, v79
  v_pk_fma_f32 v[72:73], v[48:49], v[64:65], v[72:73]
  v_pk_fma_f32 v[74:75], v[50:51], v[66:67], v[74:75]
  v_pk_fma_f32 v[12:13], v[72:73], v[76:77], v[12:13]
  v_pk_fma_f32 v[14:15], v[74:75], v[78:79], v[14:15]
  s_branch K2_FLUSH
K2_TS:
  s_waitcnt vmcnt(2)
  v_pk_fma_f32 v[64:65], v[24:25], v[4:5], v[8:9] op_sel_hi:[0,1,1]
  v_pk_fma_f32 v[66:67], v[24:25], v[6:7], v[10:11] op_sel_hi:[0,1,1]
  v_pk_fma_f32 v[68:69], v[24:25], v[4:5], v[8:9] op_sel:[1,0,0] op_sel_hi:[1,1,1]
  v_pk_fma_f32 v[70:71], v[24:25], v[6:7], v[10:11] op_sel:[1,0,0] op_sel_hi:[1,1,1]
  v_exp_f32 v64, v64
  v_exp_f32 v65, v65
  v_exp_f32 v66, v66
  v_exp_f32 v67, v67
  v_exp_f32 v68, v68
  v_exp_f32 v69, v69
  v_exp_f32 v70, v70
  v_exp_f32 v71, v71
  v_fma_mix_f32 v64, v36, v64, 1.0 op_sel_hi:[1,0,0]
  v_fma_mix_f32 v65, v37, v65, 1.0 op_sel_hi:[1,0,0]
  v_fma_mix_f32 v66, v38, v66, 1.0 op_sel_hi:[1,0,0]
  v_fma_mix_f32 v67, v39, v67, 1.0 op_sel_hi:[1,0,0]
  v_fma_mix_f32 v68, v40, v68, 1.0 op_sel_hi:[1,0,0]
  v_fma_mix_f32 v69, v41, v69, 1.0 op_sel_hi:[1,0,0]
  v_fma_mix_f32 v70, v42, v70, 1.0 op_sel_hi:[1,0,0]
  v_fma_mix_f32 v71, v43, v71, 1.0 op_sel_hi:[1,0,0]
  v_pk_mul_f32 v[76:77], v[64:65], v[68:69]
  v_pk_mul_f32 v[78:79], v[66:67], v[70:71]
  v_pk_mul_f32 v[72:73], v[36:37], v[68:69]
  v_pk_mul_f32 v[74:75], v[38:39], v[70:71]
  v_rcp_f32 v76, v76
  v_rcp_f32 v77, v77
  v_rcp_f32 v78, v78
  v_rcp_f32 v79, v79
  v_pk_fma_f32 v[72:73], v[40:41], v[64:65], v[72:73]
  v_pk_fma_f32 v[74:75], v[42:43], v[66:67], v[74:75]
  v_pk_fma_f32 v[12:13], v[72:73], v[76:77], v[12:13]
  v_pk_fma_f32 v[14:15], v[74:75], v[78:79], v[14:15]
  s_cmp_eq_u32 s65, 1
  s_cbranch_scc1 K2_FLUSH
  s_waitcnt vmcnt(0)
  v_pk_fma_f32 v[64:65], v[26:27], v[4:5], v[8:9] op_sel_hi:[0,1,1]
  v_pk_fma_f32 v[66:67], v[26:27], v[6:7], v[10:11] op_sel_hi:[0,1,1]
  v_pk_fma_f32 v[68:69], v[26:27], v[4:5], v[8:9] op_sel:[1,0,0] op_sel_hi:[1,1,1]
  v_pk_fma_f32 v[70:71], v[26:27], v[6:7], v[10:11] op_sel:[1,0,0] op_sel_hi:[1,1,1]
  v_exp_f32 v64, v64
  v_exp_f32 v65, v65
  v_exp_f32 v66, v66
  v_exp_f32 v67, v67
  v_exp_f32 v68, v68
  v_exp_f32 v69, v69
  v_exp_f32 v70, v70
  v_exp_f32 v71, v71
  v_fma_mix_f32 v64, v44, v64, 1.0 op_sel_hi:[1,0,0]
  v_fma_mix_f32 v65, v45, v65, 1.0 op_sel_hi:[1,0,0]
  v_fma_mix_f32 v66, v46, v66, 1.0 op_sel_hi:[1,0,0]
  v_fma_mix_f32 v67, v47, v67, 1.0 op_sel_hi:[1,0,0]
  v_fma_mix_f32 v68, v48, v68, 1.0 op_sel_hi:[1,0,0]
  v_fma_mix_f32 v69, v49, v69, 1.0 op_sel_hi:[1,0,0]
  v_fma_mix_f32 v70, v50, v70, 1.0 op_sel_hi:[1,0,0]
  v_fma_mix_f32 v71, v51, v71, 1.0 op_sel_hi:[1,0,0]
  v_pk_mul_f32 v[76:77], v[64:65], v[68:69]
  v_pk_mul_f32 v[78:79], v[66:67], v[70:71]
  v_pk_mul_f32 v[72:73], v[44:45], v[68:69]
  v_pk_mul_f32 v[74:75], v[46:47], v[70:71]
  v_rcp_f32 v76, v76
  v_rcp_f32 v77, v77
  v_rcp_f32 v78, v78
  v_rcp_f32 v79, v79
  v_pk_fma_f32 v[72:73], v[48:49], v[64:65], v[72:73]
  v_pk_fma_f32 v[74:75], v[50:51], v[66:67], v[74:75]
  v_pk_fma_f32 v[12:13], v[72:73], v[76:77], v[12:13]
  v_pk_fma_f32 v[14:15], v[74:75], v[78:79], v[14:15]
K2_FLUSH:
  s_cmp_eq_u32 s80, 0
  s_cbranch_scc0 K2_FLC
  ds_write_b128 v81, v[12:15] offset:28800
  s_branch K2_SEG
K2_FLC:
  v_lshlrev_b32 v8, 4, v1
  s_lshl_b32 s3, s35, 10
  s_add_u32 s3, s3, 131072
  v_add_u32 v8, s3, v8
  ds_write_b128 v8, v[12:15]
  s_lshl_b32 s3, s61, 2
  v_mov_b32 v8, s3
  s_lshl_b32 s3, 1, s35
  v_mov_b32 v9, s3
  s_mov_b64 exec, 1
  ds_or_b32 v8, v9 offset:61440
  s_mov_b64 exec, -1
  s_branch K2_SEG
K2_PRIO:
  s_cmp_eq_u32 s85, 2
  s_cbranch_scc0 K2_PRIO0
  s_setprio 1
  s_mov_b32 s85, 1
  s_movk_i32 s84, 5
  s_branch K2_PRIOR
K2_PRIO0:
  s_setprio 0
  s_movk_i32 s84, 0x7fff
  s_branch K2_PRIOR
K2_DONE:
  s_waitcnt lgkmcnt(0)
  s_setprio 0
  s_mov_b32 s48, s46
  s_and_b32 s49, s47, 0xffff
  s_mov_b32 s50, 3200000
  s_mov_b32 s51, 0x20000
  s_mul_i32 s40, s33, 25088
  s_lshl_b32 s41, s34, 6
  s_add_u32 s40, s40, s41
  v_lshrrev_b32 v63, 1, v61
  s_mov_b32 s42, 0xbfb8aa3b
  s_mov_b32 s61, s35
  s_barrier
K2_EPI:
  s_lshl_b32 s3, s61, 6
  v_add_u32 v8, s3, v62
  ds_read_b32 v9, v8 offset:59652
  s_lshl_b32 s3, s61, 2
  v_mov_b32 v11, s3
  ds_read_b32 v11, v11 offset:61440
  v_lshlrev_b32 v16, 4, v1
  v_add_u32 v16, 131072, v16
  s_waitcnt lgkmcnt(1)
  v_add_u32_sdwa v10, v9, v61 dst_sel:DWORD dst_unused:UNUSED_PAD src0_sel:WORD_0 src1_sel:DWORD
  v_lshrrev_b32 v9, 23, v9
  ds_read_b128 v[12:15], v10 offset:28800
  v_cmp_gt_u32 vcc, 196, v9
  v_lshl_add_u32 v9, v9, 7, v63
  v_add_u32 v9, s40, v9
  s_waitcnt lgkmcnt(1)
  v_readfirstlane_b32 s65, v11
  s_nop 0
K2_EPW:
  s_cmp_eq_u32 s65, 0
  s_cbranch_scc1 K2_EPX
  s_ff1_i32_b32 s66, s65
  s_bitset0_b32 s65, s66
  s_lshl_b32 s66, s66, 10
  v_add_u32 v17, s66, v16
  ds_read_b128 v[20:23], v17
  s_waitcnt lgkmcnt(0)
  v_pk_add_f32 v[12:13], v[12:13], v[20:21]
  v_pk_add_f32 v[14:15], v[14:15], v[22:23]
  s_branch K2_EPW
K2_EPX:
  s_waitcnt lgkmcnt(0)
  v_pk_mul_f32 v[20:21], v[12:13], s[42:43] op_sel_hi:[1,0]
  v_pk_mul_f32 v[22:23], v[14:15], s[42:43] op_sel_hi:[1,0]
  v_exp_f32 v20, v20
  v_exp_f32 v21, v21
  v_exp_f32 v22, v22
  v_exp_f32 v23, v23
  s_and_saveexec_b64 s[56:57], vcc
  v_pk_add_f32 v[20:21], v[20:21], 1.0 op_sel_hi:[1,0]
  v_pk_add_f32 v[22:23], v[22:23], 1.0 op_sel_hi:[1,0]
  v_rcp_f32 v20, v20
  v_rcp_f32 v21, v21
  v_rcp_f32 v22, v22
  v_rcp_f32 v23, v23
  s_nop 0
  v_pk_mul_f32 v[12:13], v[12:13], v[20:21]
  v_pk_mul_f32 v[14:15], v[14:15], v[22:23]
  v_cvt_pk_bf16_f32 v12, v12, v13
  v_cvt_pk_bf16_f32 v13, v14, v15
  s_cbranch_execz K2_EPN
  buffer_store_dwordx2 v[12:13], v9, s[48:51], 0 offen sc1
K2_EPN:
  s_mov_b64 exec, s[56:57]
  s_add_u32 s61, s61, 16
  s_cmp_lt_u32 s61, 25
  s_cbranch_scc1 K2_EPI
K2_ENDS:
K2_END:
  s_endpgm
K2_SLOW:
  s_waitcnt vmcnt(0) lgkmcnt(0)
  s_barrier
  v_cmp_gt_u32 vcc, 256, v0
  s_and_saveexec_b64 s[56:57], vcc
  s_cbranch_execz K2_SL0
  v_lshrrev_b32 v8, 2, v0
  v_lshlrev_b32 v8, 7, v8
  v_and_b32 v9, 3, v0
  v_lshl_add_u32 v8, v9, 4, v8
  s_lshl_b32 s3, s34, 6
  s_add_u32 s3, s3, 8192
  v_add_u32 v8, s3, v8
  global_load_dwordx4 v[12:15], v8, s[44:45]
  v_lshlrev_b32 v9, 4, v0
  v_add_u32 v9, 65536, v9
  s_waitcnt vmcnt(0)
  ds_write_b128 v9, v[12:15]
K2_SL0:
  s_mov_b64 exec, s[56:57]
  s_waitcnt lgkmcnt(0)
  s_barrier
  s_mov_b32 s12, s6
  s_and_b32 s13, s7, 0xffff
  s_mov_b32 s14, 3200000
  s_mov_b32 s15, 0x20000
  v_and_b32 v63, 7, v1
  v_lshlrev_b32 v63, 3, v63
  v_add_u32 v63, 65536, v63
  v_lshrrev_b32 v62, 3, v1
  s_mov_b32 s58, s35
  v_mov_b32 v25, s33
  s_movk_i32 s65, 36
K2_SLC:
  s_cmp_ge_u32 s58, 256
  s_cbranch_scc0 K2_SLC1
  v_lshlrev_b32 v62, 3, v62
  s_branch K2_DONE
K2_SLC1:
  s_lshl_b32 s3, s33, 10
  s_lshl_b32 s59, s58, 2
  s_add_u32 s3, s3, s59
  s_add_u32 s3, s3, 6422528
  v_mov_b32 v8, s3
  buffer_load_dword v9, v8, s[16:19], 0 offen
  s_waitcnt vmcnt(0)
  v_readfirstlane_b32 s60, v9
  s_nop 3
  s_lshr_b32 s64, s60, 16
  s_and_b32 s64, s64, 0x7fff
  s_and_b32 s61, s60, 0xffff
  s_cmp_gt_u32 s61, 32
  s_cselect_b32 s64, s64, 0
  s_min_u32 s61, s61, 32
  s_add_u32 s60, s61, 0
  s_add_u32 s61, s61, s64
  s_mul_i32 s62, s58, 25024
  s_lshl_b32 s66, s33, 8
  s_add_u32 s66, s66, s58
  s_mul_i32 s66, s66, 192
  s_add_u32 s66, s66, 13041664
  s_add_u32 s67, s66, 128
  s_mov_b32 s63, 0
K2_SLJ:
  s_cmp_ge_u32 s63, s61
  s_cbranch_scc1 K2_SLN
  v_add_u32 v8, s63, v62
  v_cmp_gt_u32 vcc, s61, v8
  s_and_saveexec_b64 s[56:57], vcc
  s_cbranch_execz K2_SLX
  v_cmp_gt_u32 vcc, s60, v8
  s_mov_b64 s[70:71], vcc
  s_mov_b64 s[72:73], exec
  s_and_b64 exec, exec, vcc
  s_cbranch_execz K2_SLA
  v_lshl_add_u32 v9, v8, 2, s66
  buffer_load_dword v10, v9, s[16:19], 0 offen
  v_lshl_add_u32 v9, v8, 1, s67
  buffer_load_ushort v11, v9, s[16:19], 0 offen
K2_SLA:
  s_andn2_b64 exec, s[72:73], s[70:71]
  s_cbranch_execz K2_SLB
  v_subrev_u32 v8, s60, v8
  v_lshl_add_u32 v8, v8, 3, s62
  buffer_load_dwordx2 v[10:11], v8, s[16:19], 0 offen
K2_SLB:
  s_mov_b64 exec, s[72:73]
  s_waitcnt vmcnt(0)
  v_cmp_eq_u32_sdwa vcc, v11, v25 src0_sel:WORD_1 src1_sel:DWORD
  v_and_b32 v11, 0xffff, v11
  v_lshlrev_b32 v9, 0, v11
  v_cndmask_b32 v11, v11, v9, s[70:71]
  s_or_b64 vcc, vcc, s[70:71]
  s_and_b64 exec, exec, vcc
  s_cbranch_execz K2_SLX
  v_and_b32 v16, 0xffff, v10
  v_and_b32 v24, 0xffff0000, v10
  v_mad_u32_u24 v53, v11, s65, v61
  ds_read_b128 v[12:15], v53 offset:0
  buffer_load_dwordx4 v[28:31], v[16:17], s[24:27], 0 idxen offen
  v_lshlrev_b32 v18, 7, v16
  v_mov_b32 v19, v63
  v_mov_b32 v44, 0
  v_mov_b32 v45, 0
  v_mov_b32 v46, 0
  v_mov_b32 v47, 0
  s_mov_b32 s64, 0
K2_SLK:
  buffer_load_dwordx4 v[32:35], v18, s[12:15], s64 offen
  ds_read_b64 v[64:65], v19 offset:0
  ds_read_b64 v[66:67], v19 offset:64
  ds_read_b64 v[68:69], v19 offset:128
  ds_read_b64 v[70:71], v19 offset:192
  ds_read_b64 v[72:73], v19 offset:256
  ds_read_b64 v[74:75], v19 offset:320
  ds_read_b64 v[76:77], v19 offset:384
  ds_read_b64 v[78:79], v19 offset:448
  s_waitcnt vmcnt(0) lgkmcnt(0)
  v_lshlrev_b32 v36, 16, v32
  v_lshlrev_b32 v37, 16, v64
  v_and_b32 v38, 0xffff0000, v64
  v_lshlrev_b32 v39, 16, v65
  v_and_b32 v40, 0xffff0000, v65
  v_fmac_f32 v44, v36, v37
  v_fmac_f32 v45, v36, v38
  v_fmac_f32 v46, v36, v39
  v_fmac_f32 v47, v36, v40
  v_and_b32 v36, 0xffff0000, v32
  v_lshlrev_b32 v37, 16, v66
  v_and_b32 v38, 0xffff0000, v66
  v_lshlrev_b32 v39, 16, v67
  v_and_b32 v40, 0xffff0000, v67
  v_fmac_f32 v44, v36, v37
  v_fmac_f32 v45, v36, v38
  v_fmac_f32 v46, v36, v39
  v_fmac_f32 v47, v36, v40
  v_lshlrev_b32 v36, 16, v33
  v_lshlrev_b32 v37, 16, v68
  v_and_b32 v38, 0xffff0000, v68
  v_lshlrev_b32 v39, 16, v69
  v_and_b32 v40, 0xffff0000, v69
  v_fmac_f32 v44, v36, v37
  v_fmac_f32 v45, v36, v38
  v_fmac_f32 v46, v36, v39
  v_fmac_f32 v47, v36, v40
  v_and_b32 v36, 0xffff0000, v33
  v_lshlrev_b32 v37, 16, v70
  v_and_b32 v38, 0xffff0000, v70
  v_lshlrev_b32 v39, 16, v71
  v_and_b32 v40, 0xffff0000, v71
  v_fmac_f32 v44, v36, v37
  v_fmac_f32 v45, v36, v38
  v_fmac_f32 v46, v36, v39
  v_fmac_f32 v47, v36, v40
  v_lshlrev_b32 v36, 16, v34
  v_lshlrev_b32 v37, 16, v72
  v_and_b32 v38, 0xffff0000, v72
  v_lshlrev_b32 v39, 16, v73
  v_and_b32 v40, 0xffff0000, v73
  v_fmac_f32 v44, v36, v37
  v_fmac_f32 v45, v36, v38
  v_fmac_f32 v46, v36, v39
  v_fmac_f32 v47, v36, v40
  v_and_b32 v36, 0xffff0000, v34
  v_lshlrev_b32 v37, 16, v74
  v_and_b32 v38, 0xffff0000, v74
  v_lshlrev_b32 v39, 16, v75
  v_and_b32 v40, 0xffff0000, v75
  v_fmac_f32 v44, v36, v37
  v_fmac_f32 v45, v36, v38
  v_fmac_f32 v46, v36, v39
  v_fmac_f32 v47, v36, v40
  v_lshlrev_b32 v36, 16, v35
  v_lshlrev_b32 v37, 16, v76
  v_and_b32 v38, 0xffff0000, v76
  v_lshlrev_b32 v39, 16, v77
  v_and_b32 v40, 0xffff0000, v77
  v_fmac_f32 v44, v36, v37
  v_fmac_f32 v45, v36, v38
  v_fmac_f32 v46, v36, v39
  v_fmac_f32 v47, v36, v40
  v_and_b32 v36, 0xffff0000, v35
  v_lshlrev_b32 v37, 16, v78
  v_and_b32 v38, 0xffff0000, v78
  v_lshlrev_b32 v39, 16, v79
  v_and_b32 v40, 0xffff0000, v79
  v_fmac_f32 v44, v36, v37
  v_fmac_f32 v45, v36, v38
  v_fmac_f32 v46, v36, v39
  v_fmac_f32 v47, v36, v40
  v_add_u32 v19, 512, v19
  s_add_u32 s64, s64, 16
  s_cmp_lt_u32 s64, 128
  s_cbranch_scc1 K2_SLK
  s_mov_b32 s3, 0xbfb8aa3b
  v_fma_f32 v12, v24, v4, v12
  v_fma_f32 v13, v24, v5, v13
  v_fma_f32 v14, v24, v6, v14
  v_fma_f32 v15, v24, v7, v15
  v_fma_f32 v12, v44, s3, v12
  v_fma_f32 v13, v45, s3, v13
  v_fma_f32 v14, v46, s3, v14
  v_fma_f32 v15, v47, s3, v15
  v_exp_f32 v12, v12
  v_exp_f32 v13, v13
  v_exp_f32 v14, v14
  v_exp_f32 v15, v15
  s_nop 0
  v_add_f32 v12, 1.0, v12
  v_add_f32 v13, 1.0, v13
  v_add_f32 v14, 1.0, v14
  v_add_f32 v15, 1.0, v15
  v_rcp_f32 v12, v12
  v_rcp_f32 v13, v13
  v_rcp_f32 v14, v14
  v_rcp_f32 v15, v15
  s_nop 0
  v_mul_f32 v12, v12, v28
  v_mul_f32 v13, v13, v29
  v_mul_f32 v14, v14, v30
  v_mul_f32 v15, v15, v31
  ds_add_f32 v53, v12 offset:28800
  ds_add_f32 v53, v13 offset:28804
  ds_add_f32 v53, v14 offset:28808
  ds_add_f32 v53, v15 offset:28812
K2_SLX:
  s_mov_b64 exec, s[56:57]
  s_add_u32 s63, s63, 8
  s_branch K2_SLJ
K2_SLN:
  s_add_u32 s58, s58, 16
  s_branch K2_SLC
K2_CODE_END:
.section .rodata,"a"
.p2align 6
.amdhsa_kernel k1_kernel
  .amdhsa_next_free_vgpr 104
  .amdhsa_next_free_sgpr 96
  .amdhsa_accum_offset 104
  .amdhsa_group_segment_fixed_size 0
  .amdhsa_kernarg_size 80
  .amdhsa_user_sgpr_count 2
  .amdhsa_user_sgpr_kernarg_segment_ptr 1
  .amdhsa_system_sgpr_workgroup_id_x 1
.end_amdhsa_kernel
.section .rodata,"a"
.p2align 6
.amdhsa_kernel k2_kernel
  .amdhsa_next_free_vgpr 128
  .amdhsa_next_free_sgpr 100
  .amdhsa_accum_offset 128
  .amdhsa_group_segment_fixed_size 0
  .amdhsa_kernarg_size 80
  .amdhsa_user_sgpr_count 2
  .amdhsa_user_sgpr_kernarg_segment_ptr 1
  .amdhsa_system_sgpr_workgroup_id_x 1
.end_amdhsa_kernel
```
